```python
import torch

def _softmax(x, axis=-1):
    return torch.softmax(x, dim=axis)
def _gelu(x):
    return torch.nn.functional.gelu(x, approximate="tanh")
def _silu(x):
    return torch.nn.functional.silu(x)
def _sigmoid(x):
    return torch.sigmoid(x)
def _layernorm(x, axis=-1, eps=1e-5):
    m = x.mean(dim=axis, keepdim=True)
    v = x.var(dim=axis, keepdim=True, unbiased=False)
    return (x - m) / torch.sqrt(v + eps)
def _scatter_add(tgt, idx, src, axis=0):
    return tgt.clone().index_add_(axis, idx, src)
def _segment_sum(src, seg, n):
    out = torch.zeros((n,) + src.shape[1:], dtype=src.dtype)
    return out.index_add_(0, seg, src)
def _pad(x, pw):
    flat = tuple(v for pair in reversed(pw) for v in pair)
    return torch.nn.functional.pad(x, flat)

kernel_name = 'gather_scatter__mpnn_edge_mlp__graph'

def setup_inputs():

    _w = (lambda a: (lambda t: t.to(torch.bfloat16) if t.is_floating_point() else t)(torch.as_tensor(a)))
    N, deg, D, De = 12500, 32, 128, max(4, 1)
    E = N * deg
    return {
        "x": _w((lambda *s: torch.randn(*s, dtype=torch.bfloat16) * 0.05)(N, D)),
        "e_attr": _w((lambda *s: torch.randn(*s, dtype=torch.bfloat16) * 0.4)(E, De)),
        "src": _w((lambda lo, hi, *s: torch.randint(lo, hi, s))(0, N, E).to(torch.int64)),
        "dst": _w((lambda lo, hi, *s: torch.randint(lo, hi, s))(0, N, E).to(torch.int64)),
        "w_msg": _w((lambda *s: torch.randn(*s, dtype=torch.bfloat16) * 0.4)(2 * D + De, D)),
        "w_upd": _w((lambda *s: torch.randn(*s, dtype=torch.bfloat16) * 0.05)(2 * D, D)),
    }

def reference(x, e_attr, src, dst, w_msg, w_upd):
    N, D = x.shape
    m_in = torch.concatenate([x[src], x[dst], e_attr], axis=-1)
    msg = _silu(m_in @ w_msg)
    agg = _segment_sum(msg, dst, N)
    return _silu(torch.concatenate([x, agg], axis=-1) @ w_upd)
```

```asm
; @launch grid=(256,1,1) block=(1024,1,1) lds=163840
.amdgcn_target "amdgcn-amd-amdhsa--gfx950"
.text
.globl gather_scatter__mpnn_edge_mlp__graph_kernel
.p2align 8
.type gather_scatter__mpnn_edge_mlp__graph_kernel,@function
gather_scatter__mpnn_edge_mlp__graph_kernel:
s_cmp_ge_u32 s2, 256
s_cbranch_scc1 k_end
s_load_dwordx16 s[4:19], s[0:1], 0
s_load_dwordx2 s[20:21], s[0:1], 64
s_and_b32 s3, s2, 7
s_lshl_b32 s3, s3, 5
s_lshr_b32 s23, s2, 3
s_add_u32 s3, s3, s23
s_mov_b32 s22, 0
s_mov_b32 s23, s3
s_mov_b32 s50, 0
k_go:
v_lshrrev_b32 v1, 6, v0
v_lshlrev_b32 v2, 4, v0
v_readfirstlane_b32 s48, v1
s_mov_b32 s39, 0x00020000
s_mov_b32 s43, 0x00020000
s_mov_b32 s47, 0x00020000
s_cmp_gt_u32 s48, 7
s_cbranch_scc1 k_gemm
s_setprio 3
v_and_b32 v52, 0x3f0, v2
v_add_u32 v53, 97792, v52
v_mov_b32 v12, 16
s_cmp_eq_u32 s48, 7
s_cbranch_scc1 k_help
s_mul_i32 s56, s23, 6256
s_sub_u32 s57, 1600000, s56
s_min_u32 s57, s57, 6256
v_cmp_gt_u32 s[58:59], s57, v2
s_lshl_b32 s57, s56, 1
v_lshlrev_b32 v3, 1, v2
v_mov_b64 v[16:17], 0
v_mov_b64 v[20:21], 0
v_mov_b64 v[24:25], 0
v_mov_b64 v[28:29], 0
v_mov_b32 v14, 0
s_mov_b32 s38, 1600000
s_mov_b32 s42, 1600000
s_mov_b32 s46, 3200000
s_mov_b64 exec, s[58:59]
s_waitcnt lgkmcnt(0)
s_mov_b64 s[36:37], s[10:11]
buffer_load_dwordx4 v[4:7], v2, s[36:39], s56 offen
s_mov_b64 s[40:41], s[8:9]
s_mov_b64 s[44:45], s[6:7]
s_barrier
buffer_load_dwordx4 v[8:11], v2, s[40:43], s56 offen
buffer_load_dwordx4 v[16:19], v3, s[44:47], s57 offen offset:0
buffer_load_dwordx4 v[24:27], v3, s[44:47], s57 offen offset:16
s_mov_b64 exec, -1
v_add_u32 v40, 98816, v2
v_mov_b32 v32, 822083584
v_mov_b32 v33, 163456
v_mov_b64 v[34:35], v[32:33]
s_add_u32 s53, s3, 12544
v_mov_b64 v[36:37], 0
v_mov_b32 v38, s53
v_mov_b32 v39, 0
ds_write_b128 v40, v[32:35]
ds_write_b128 v40, v[36:39] offset:7680
ds_write_b128 v40, v[36:39] offset:15872
ds_write_b128 v40, v[36:39] offset:24064
s_lshr_b32 s52, s3, 2
s_lshl_b32 s52, s52, 4
s_and_b32 s53, s3, 1
s_lshl_b32 s53, s53, 3
s_add_u32 s52, s52, s53
s_and_b32 s53, s3, 2
s_lshl_b32 s53, s53, 9
s_add_u32 s52, s52, s53
v_lshrrev_b32 v3, 2, v0
v_lshlrev_b32 v3, 11, v3
s_add_u32 s49, s52, 262144
s_movk_i32 s56, 21400
s_movk_i32 s57, -49
s_mov_b32 s60, 51456
s_add_u32 s28, s20, 4194304
s_addc_u32 s29, s21, 0
s_cmp_eq_u32 s22, 2
s_cselect_b32 s30, 0, 13107200
s_mov_b32 s31, 0x00020000
s_add_u32 s32, s20, 3407872
s_addc_u32 s33, s21, 0
s_mov_b32 s34, 528384
s_mov_b32 s35, 0x00020000
s_mul_i32 s62, s48, 3584
v_add_u32 v54, s62, v52
s_mul_i32 s62, s23, 51200
s_cmp_eq_u32 s22, 1
s_cselect_b32 s63, 25600, 0
s_add_u32 s62, s62, s63
s_mov_b32 s63, 0x7fff7fff
v_mov_b64 v[56:57], 0
v_mov_b64 v[58:59], 0
s_mov_b64 exec, s[58:59]
s_waitcnt vmcnt(3)
v_mul_u32_u24 v32, s56, v4
v_mul_u32_u24 v33, s56, v5
v_mul_u32_u24 v34, s56, v6
v_mul_u32_u24 v35, s56, v7
v_lshrrev_b32 v32, 20, v32
v_lshrrev_b32 v33, 20, v33
v_lshrrev_b32 v34, 20, v34
v_lshrrev_b32 v35, 20, v35
v_lshl_add_u32 v36, v32, 2, s60
ds_add_rtn_u32 v40, v36, v12 offset:46336
v_lshl_add_u32 v37, v33, 2, s60
ds_add_rtn_u32 v41, v37, v12 offset:46336
v_lshl_add_u32 v38, v34, 2, s60
ds_add_rtn_u32 v42, v38, v12 offset:46336
v_lshl_add_u32 v39, v35, 2, s60
ds_add_rtn_u32 v43, v39, v12 offset:46336
s_mov_b64 exec, 1
ds_add_u32 v14, v12 offset:51420
s_mov_b64 exec, -1
v_mad_i32_i24 v4, v32, s57, v4
v_bfe_i32 v32, v4, 0, 3
v_and_b32 v32, 15, v32
v_lshl_or_b32 v4, v4, 4, v32
v_mad_i32_i24 v5, v33, s57, v5
v_bfe_i32 v33, v5, 0, 3
v_and_b32 v33, 15, v33
v_lshl_or_b32 v5, v5, 4, v33
v_mad_i32_i24 v6, v34, s57, v6
v_bfe_i32 v34, v6, 0, 3
v_and_b32 v34, 15, v34
v_lshl_or_b32 v6, v6, 4, v34
v_mad_i32_i24 v7, v35, s57, v7
v_bfe_i32 v35, v7, 0, 3
v_and_b32 v35, 15, v35
v_lshl_or_b32 v7, v7, 4, v35
k_sp1:
ds_read_b32 v15, v14 offset:51420
ds_read_b128 v[44:47], v53
s_waitcnt lgkmcnt(0)
v_readfirstlane_b32 s61, v15
v_add_u32 v49, v44, v45
v_add_u32 v50, v49, v46
v_add_u32 v48, v50, v47
v_add_u32 v51, v50, v47
s_cmp_lt_u32 s61, 112
s_cbranch_scc1 k_sp1c
v_add_u32_dpp v48, v48, v48 row_shr:1
s_nop 1
v_add_u32_dpp v48, v48, v48 row_shr:2
s_nop 1
v_add_u32_dpp v48, v48, v48 row_shr:4
s_nop 1
v_add_u32_dpp v48, v48, v48 row_shr:8
s_nop 1
v_add_u32_dpp v48, v48, v48 row_bcast:15 row_mask:0xa
s_nop 1
v_add_u32_dpp v48, v48, v48 row_bcast:31 row_mask:0xc
v_sub_u32 v48, v48, v51
v_add_u32 v51, v48, v50
v_add_u32 v50, v48, v49
v_add_u32 v49, v48, v44
ds_write_b128 v52, v[48:51] offset:51456
s_mov_b64 exec, s[58:59]
ds_read_b32 v36, v36
ds_read_b32 v37, v37
ds_read_b32 v38, v38
ds_read_b32 v39, v39
s_waitcnt vmcnt(2)
v_lshl_or_b32 v22, v5, 20, v9
v_lshl_or_b32 v30, v7, 20, v11
s_waitcnt vmcnt(1) lgkmcnt(3)
v_mov_b64 v[20:21], v[18:19]
v_lshl_or_b32 v18, v4, 20, v8
v_add_u32 v40, v40, v36
ds_write_b96 v40, v[16:18] offset:25600
s_waitcnt lgkmcnt(3)
v_add_u32 v41, v41, v37
ds_write_b96 v41, v[20:22] offset:25600
s_waitcnt vmcnt(0) lgkmcnt(3)
v_mov_b64 v[28:29], v[26:27]
v_lshl_or_b32 v26, v6, 20, v10
v_add_u32 v42, v42, v38
ds_write_b96 v42, v[24:26] offset:25600
s_waitcnt lgkmcnt(3)
v_add_u32 v43, v43, v39
ds_write_b96 v43, v[28:30] offset:25600
s_mov_b64 exec, 1
ds_add_u32 v14, v12 offset:51416
s_mov_b64 exec, -1
v_and_b32 v32, s63, v16
v_and_b32 v33, s63, v17
v_and_b32 v34, s63, v20
v_and_b32 v35, s63, v21
v_and_b32 v36, s63, v24
v_and_b32 v37, s63, v25
v_and_b32 v38, s63, v28
v_and_b32 v39, s63, v29
v_pk_max_u16 v32, v32, v36
v_pk_max_u16 v33, v33, v37
v_pk_max_u16 v34, v34, v38
v_pk_max_u16 v35, v35, v39
v_pk_max_u16 v32, v32, v33
v_pk_max_u16 v34, v34, v35
v_pk_max_u16 v13, v32, v34
v_max_u32_sdwa v13, v13, v13 dst_sel:DWORD dst_unused:UNUSED_PAD src0_sel:WORD_0 src1_sel:WORD_1
k_sp2:
ds_read_b96 v[44:46], v14 offset:51408
ds_read_b128 v[64:67], v54 offset:25600
ds_read_b128 v[68:71], v54 offset:26496
ds_read_b128 v[72:75], v54 offset:27392
ds_read_b128 v[76:79], v54 offset:28288
s_waitcnt lgkmcnt(4)
v_readfirstlane_b32 s61, v46
s_cmp_lt_u32 s61, 128
s_cbranch_scc1 k_sp2c
s_mov_b32 exec_hi, 0x00ffffff
s_waitcnt lgkmcnt(3)
v_mov_b32 v67, v44
buffer_store_dwordx4 v[64:67], v54, s[28:31], s62 offen offset:0 sc0 sc1
ds_write_b128 v54, v[56:59] offset:25600
s_waitcnt lgkmcnt(3)
v_mov_b32 v71, v44
buffer_store_dwordx4 v[68:71], v54, s[28:31], s62 offen offset:896 sc0 sc1
ds_write_b128 v54, v[56:59] offset:26496
s_waitcnt lgkmcnt(3)
v_mov_b32 v75, v44
buffer_store_dwordx4 v[72:75], v54, s[28:31], s62 offen offset:1792 sc0 sc1
ds_write_b128 v54, v[56:59] offset:27392
s_waitcnt lgkmcnt(3)
v_mov_b32 v79, v44
buffer_store_dwordx4 v[76:79], v54, s[28:31], s62 offen offset:2688 sc0 sc1
ds_write_b128 v54, v[56:59] offset:28288
s_mov_b64 exec, -1
v_max_u32_dpp v13, v13, v13 row_shr:1
s_nop 1
v_max_u32_dpp v13, v13, v13 row_shr:2
s_nop 1
v_max_u32_dpp v13, v13, v13 row_shr:4
s_nop 1
v_max_u32_dpp v13, v13, v13 row_shr:8
s_nop 1
v_max_u32_dpp v13, v13, v13 row_bcast:15 row_mask:0xa
s_nop 1
v_max_u32_dpp v13, v13, v13 row_bcast:31 row_mask:0xc
s_mov_b32 exec_lo, 0
s_mov_b32 exec_hi, 0x80000000
ds_max_u32 v14, v13 offset:51404
ds_add_u32 v14, v12 offset:51440
s_mov_b64 exec, -1
v_readfirstlane_b32 s54, v44
v_readfirstlane_b32 s55, v45
s_branch k_setup
k_help:
s_memrealtime s[58:59]
v_lshlrev_b32 v9, 3, v52
s_getpc_b64 s[40:41]
k_pc:
s_mov_b32 s42, code_end-k_pc
s_lshr_b32 s57, s2, 3
s_mul_i32 s56, s57, 768
s_mov_b64 exec, 0x3f
buffer_load_dword v26, v9, s[40:43], s56 offen
s_mov_b64 exec, -1
v_mov_b64 v[4:5], 0
v_mov_b64 v[6:7], 0
ds_write_b128 v53, v[4:7]
s_mov_b32 exec_hi, 0
ds_write_b128 v52, v[4:7] offset:50688
s_mov_b32 exec_hi, -1
v_and_b32 v8, 63, v0
s_movk_i32 s56, 1152
v_mov_b32 v9, 107008
v_mad_u32_u24 v9, v8, s56, v9
v_cmp_gt_u32 vcc, 49, v8
s_nop 1
v_cndmask_b32 v9, 0, v9, vcc
s_mov_b32 s56, 98816
v_writelane_b32 v9, s56, 63
v_lshlrev_b32 v8, 2, v8
ds_write_b32 v8, v9 offset:51200
v_and_b32 v8, 3, v0
v_bfe_u32 v11, v0, 2, 2
v_bfe_u32 v10, v0, 4, 2
v_lshlrev_b32 v8, 3, v8
v_lshl_or_b32 v8, v11, 6, v8
v_lshl_or_b32 v8, v10, 1, v8
v_lshlrev_b32 v9, 3, v52
s_movk_i32 s38, 256
s_mov_b32 s46, 66560
s_mul_i32 s56, s57, 2176
s_lshl_b32 s57, s57, 11
s_mov_b32 s42, 65536
s_mov_b32 s60, 131200
v_mov_b32 v11, 4219968
v_mad_u32_u24 v11, v52, s60, v11
s_mov_b32 s60, 0
v_writelane_b32 v11, s60, 7
s_mov_b32 s60, 4128768
v_writelane_b32 v11, s60, 8
s_mov_b32 s30, 17301504
s_mov_b32 s31, 0x00020000
s_waitcnt lgkmcnt(0)
s_mov_b64 s[44:45], s[12:13]
s_mov_b64 exec, 0x1ffff
buffer_load_dword v27, v9, s[44:47], s56 offen
s_mov_b64 s[40:41], s[14:15]
s_mov_b64 exec, 0xffff
buffer_load_dword v25, v9, s[40:43], s57 offen
s_mov_b64 exec, -1
s_mov_b64 s[36:37], s[18:19]
s_cmp_gt_u32 s2, 7
s_cbranch_scc1 k_h1
s_or_b32 s58, s58, 1
v_mov_b32 v4, s58
v_mov_b32 v5, s59
s_mov_b64 exec, 1
buffer_atomic_cmpswap_x2 v[4:7], off, s[36:39], 0 sc1
s_mov_b64 exec, -1
k_h1:
s_barrier
s_mov_b64 s[28:29], s[20:21]
s_mov_b64 exec, 0x1ff
buffer_load_dword v24, v11, s[28:31], 0 offen
s_mov_b64 exec, -1
s_mov_b64 s[28:29], s[16:17]
s_mov_b32 s30, 3200000
s_mul_i32 s56, s3, 12544
buffer_load_dword v24, off, s[28:31], s56
s_mov_b32 s56, 65536
buffer_load_ushort v16, v8, s[44:47], s56 offen offset:0
buffer_load_ushort v20, v8, s[44:47], s56 offen offset:32
buffer_load_ushort v17, v8, s[44:47], s56 offen offset:256
buffer_load_ushort v21, v8, s[44:47], s56 offen offset:288
buffer_load_ushort v18, v8, s[44:47], s56 offen offset:512
buffer_load_ushort v22, v8, s[44:47], s56 offen offset:544
buffer_load_ushort v19, v8, s[44:47], s56 offen offset:768
buffer_load_ushort v23, v8, s[44:47], s56 offen offset:800
s_mov_b64 s[40:41], s[14:15]
s_mov_b32 s42, 65536
s_lshr_b32 s57, s2, 3
s_lshl_b32 s57, s57, 11
s_mov_b64 exec, 0xffff
s_add_u32 s40, s20, 4096
s_addc_u32 s41, s21, 0
s_mov_b32 s42, 3276800
s_lshl_b32 s56, s3, 8
s_add_u32 s56, s56, 3211264
v_mov_b32 v28, 1106788856
v_mov_b32 v29, 1106788856
v_mov_b32 v30, 1106788856
v_mov_b32 v31, 1106788856
buffer_store_dwordx4 v[28:31], v52, s[40:43], s56 offen sc0 sc1
s_mov_b64 exec, -1
v_add_u32 v40, 98816, v2
v_mov_b32 v32, 822083584
v_mov_b32 v33, 163456
v_mov_b64 v[34:35], v[32:33]
s_add_u32 s53, s3, 12544
v_mov_b64 v[36:37], 0
v_mov_b32 v38, s53
v_mov_b32 v39, 0
ds_write_b128 v40, v[32:35]
ds_write_b128 v40, v[36:39] offset:7680
ds_write_b128 v40, v[36:39] offset:15872
ds_write_b128 v40, v[36:39] offset:24064
s_lshr_b32 s52, s3, 2
s_lshl_b32 s52, s52, 4
s_and_b32 s53, s3, 1
s_lshl_b32 s53, s53, 3
s_add_u32 s52, s52, s53
s_and_b32 s53, s3, 2
s_lshl_b32 s53, s53, 9
s_add_u32 s52, s52, s53
v_lshrrev_b32 v3, 2, v0
v_lshlrev_b32 v3, 11, v3
s_add_u32 s49, s52, 262144
s_add_u32 s32, s20, 3407872
s_addc_u32 s33, s21, 0
s_cmp_eq_u32 s22, 2
s_cselect_b32 s34, 0, 528384
s_mov_b32 s35, 0x00020000
s_cmp_eq_u32 s22, 1
s_cselect_b32 s57, 25600, 0
s_lshl_b32 s56, s23, 11
s_load_dwordx2 s[54:55], s[18:19], 0
k_sp1h:
ds_read_b32 v15, v6 offset:51420
ds_read_b128 v[44:47], v53
s_waitcnt lgkmcnt(0)
v_readfirstlane_b32 s61, v15
v_add_u32 v49, v44, v45
v_add_u32 v50, v49, v46
v_add_u32 v48, v50, v47
v_add_u32 v51, v50, v47
s_cmp_lt_u32 s61, 112
s_cbranch_scc1 k_sp1hc
v_add_u32_dpp v48, v48, v48 row_shr:1
s_nop 1
v_add_u32_dpp v48, v48, v48 row_shr:2
s_nop 1
v_add_u32_dpp v48, v48, v48 row_shr:4
s_nop 1
v_add_u32_dpp v48, v48, v48 row_shr:8
s_nop 1
v_add_u32_dpp v48, v48, v48 row_bcast:15 row_mask:0xa
s_nop 1
v_add_u32_dpp v48, v48, v48 row_bcast:31 row_mask:0xc
v_mov_b32 v10, s54
v_mov_b32 v11, s55
v_sub_u32 v48, v48, v51
s_cmp_eq_u32 s54, 0
s_cbranch_scc1 k_nofb
k_have:
s_mov_b64 exec, 1
ds_write_b64 v6, v[10:11] offset:51408
ds_add_u32 v6, v12 offset:51416
s_mov_b64 exec, -1
s_lshr_b64 s[60:61], s[54:55], 5
s_lshl_b32 s59, s54, 27
s_add_u32 s57, s59, s57
v_add_u32 v48, s57, v48
v_lshl_add_u32 v56, v44, 12, v48
v_mov_b32 v57, s60
v_add_u32 v58, v48, v44
v_lshl_add_u32 v58, v45, 12, v58
v_mov_b32 v59, s60
buffer_store_dwordx4 v[56:59], v52, s[32:35], s56 offen sc0 sc1
v_add_u32 v60, v48, v49
v_lshl_add_u32 v60, v46, 12, v60
v_mov_b32 v61, s60
v_add_u32 v62, v48, v50
v_lshl_add_u32 v62, v47, 12, v62
v_mov_b32 v63, s60
buffer_store_dwordx4 v[60:63], v52, s[32:35], s56 offen offset:1024 sc0 sc1
s_waitcnt vmcnt(2)
s_mov_b32 s56, 0xbfb8aa3b
v_lshlrev_b32 v16, 16, v16
v_mul_f32 v16, s56, v16
v_lshlrev_b32 v17, 16, v17
v_mul_f32 v17, s56, v17
v_lshlrev_b32 v18, 16, v18
v_mul_f32 v18, s56, v18
v_lshlrev_b32 v19, 16, v19
v_mul_f32 v19, s56, v19
v_lshlrev_b32 v20, 16, v20
v_mul_f32 v20, s56, v20
v_lshlrev_b32 v21, 16, v21
v_mul_f32 v21, s56, v21
v_lshlrev_b32 v22, 16, v22
v_mul_f32 v22, s56, v22
v_lshlrev_b32 v23, 16, v23
v_mul_f32 v23, s56, v23
v_cvt_pk_bf16_f32 v30, v16, v17
v_cvt_pk_bf16_f32 v31, v18, v19
v_cvt_pk_bf16_f32 v28, v20, v21
v_cvt_pk_bf16_f32 v29, v22, v23
v_max_f32 v16, |v16|, |v20|
v_max_f32 v17, |v17|, |v21|
v_max_f32 v18, |v18|, |v22|
v_max_f32 v19, |v19|, |v23|
v_max_u32_dpp v16, v16, v16 row_shr:1
v_max_u32_dpp v17, v17, v17 row_shr:1
v_max_u32_dpp v18, v18, v18 row_shr:1
v_max_u32_dpp v19, v19, v19 row_shr:1
v_max_u32_dpp v16, v16, v16 row_shr:2
v_max_u32_dpp v17, v17, v17 row_shr:2
v_max_u32_dpp v18, v18, v18 row_shr:2
v_max_u32_dpp v19, v19, v19 row_shr:2
v_max_u32_dpp v16, v16, v16 row_shr:4
v_max_u32_dpp v17, v17, v17 row_shr:4
v_max_u32_dpp v18, v18, v18 row_shr:4
v_max_u32_dpp v19, v19, v19 row_shr:4
v_max_u32_dpp v16, v16, v16 row_shr:8
v_max_u32_dpp v17, v17, v17 row_shr:8
v_max_u32_dpp v18, v18, v18 row_shr:8
v_max_u32_dpp v19, v19, v19 row_shr:8
v_max_u32_dpp v16, v16, v16 row_bcast:15 row_mask:0xa
v_max_u32_dpp v17, v17, v17 row_bcast:15 row_mask:0xa
v_max_u32_dpp v18, v18, v18 row_bcast:15 row_mask:0xa
v_max_u32_dpp v19, v19, v19 row_bcast:15 row_mask:0xa
v_max_u32_dpp v16, v16, v16 row_bcast:31 row_mask:0xc
v_max_u32_dpp v17, v17, v17 row_bcast:31 row_mask:0xc
v_max_u32_dpp v18, v18, v18 row_bcast:31 row_mask:0xc
v_max_u32_dpp v19, v19, v19 row_bcast:31 row_mask:0xc
v_add_f32 v16, v16, v17
v_add_f32 v18, v18, v19
v_add_f32 v16, v16, v18
v_mul_f32 v13, 0x3f8147ae, v16
s_lshl_b32 s56, s23, 4
s_add_u32 s56, s56, 524296
s_cmp_eq_u32 s22, 2
s_cselect_b32 s56, 528384, s56
s_mov_b32 s34, 528384
s_mov_b32 exec_lo, 0
s_mov_b32 exec_hi, 0x80000000
ds_write_b32 v6, v13 offset:51424
k_sp2h:
ds_read_b32 v15, v6 offset:51440
ds_read_b32 v56, v6 offset:51404
s_waitcnt lgkmcnt(0)
v_readfirstlane_b32 s61, v15
v_or_b32 v56, s59, v56
s_cmp_lt_u32 s61, 112
s_cbranch_scc1 k_sp2h
buffer_store_dwordx2 v[56:57], off, s[32:35], s56 sc0 sc1
s_mov_b64 exec, -1
ds_write_b128 v53, v[28:31]
s_branch k_setup
k_gemm:
v_and_b32 v3, 0x3f0, v2
v_bfe_u32 v10, v0, 2, 4
v_and_b32 v8, 0x30, v2
v_and_b32 v9, 0x20, v0
v_xor_b32 v8, v8, v9
v_lshl_or_b32 v10, v10, 8, v8
s_and_b32 s60, s48, 3
s_lshl_b32 s58, s60, 13
s_lshl_b32 s60, s60, 6
s_mov_b32 s46, 66560
s_mul_i32 s56, s23, 12544
s_cmp_gt_u32 s48, 11
s_cbranch_scc1 k_g0
s_setprio 2
v_and_b32 v11, 0xff0, v2
v_and_b32 v8, 0xf0, v0
v_xor_b32 v11, v11, v8
s_lshl_b32 s59, s60, 4
s_add_u32 m0, s59, 85248
v_cmp_gt_u32 vcc, 0x210, v0
s_mov_b32 s38, 3200000
s_add_u32 s58, s58, 52480
s_mov_b32 s57, s56
s_waitcnt lgkmcnt(0)
s_mov_b64 s[36:37], s[4:5]
buffer_load_dwordx4 v11, s[36:39], s57 offen lds
s_add_u32 m0, m0, 4096
s_add_u32 s57, s57, 4096
buffer_load_dwordx4 v11, s[36:39], s57 offen lds
s_add_u32 m0, m0, 4096
s_add_u32 s57, s57, 4096
buffer_load_dwordx4 v11, s[36:39], s57 offen lds
s_add_u32 m0, m0, 4096
s_add_u32 s57, s57, 4096
s_mov_b64 exec, vcc
buffer_load_dwordx4 v11, s[36:39], s57 offen lds
s_mov_b64 exec, -1
s_mov_b32 s57, s60
s_branch k_g1
k_g0:
s_add_u32 s58, s58, 131072
s_add_u32 s57, s60, 32768
s_waitcnt lgkmcnt(0)
k_g1:
s_mov_b64 s[44:45], s[12:13]
s_mov_b32 m0, s58
s_barrier
buffer_load_dwordx4 v10, s[44:47], s57 offen offset:0 lds
s_add_u32 s57, s57, 3072
buffer_load_dwordx4 v10, s[44:47], s57 offen offset:1024 lds
s_add_u32 s57, s57, 3072
buffer_load_dwordx4 v10, s[44:47], s57 offen offset:2048 lds
s_add_u32 s57, s57, 3072
buffer_load_dwordx4 v10, s[44:47], s57 offen offset:3072 lds
s_add_u32 m0, m0, 4096
s_add_u32 s57, s57, 7168
buffer_load_dwordx4 v10, s[44:47], s57 offen offset:0 lds
s_add_u32 s57, s57, 3072
buffer_load_dwordx4 v10, s[44:47], s57 offen offset:1024 lds
s_add_u32 s57, s57, 3072
buffer_load_dwordx4 v10, s[44:47], s57 offen offset:2048 lds
s_add_u32 s57, s57, 3072
buffer_load_dwordx4 v10, s[44:47], s57 offen offset:3072 lds
k_g1b:
v_and_b32 v13, 15, v0
v_bfe_u32 v12, v0, 4, 2
v_xor_b32 v4, v12, v13
v_lshlrev_b32 v4, 4, v4
v_lshl_add_u32 v4, v13, 8, v4
v_add_u32 v4, 85248, v4
v_xor_b32 v5, 64, v4
v_xor_b32 v6, 128, v4
v_xor_b32 v7, 192, v4
v_and_b32 v8, 3, v0
v_lshlrev_b32 v8, 3, v8
v_and_b32 v9, 16, v0
v_lshl_or_b32 v8, v9, 1, v8
v_and_b32 v9, 12, v0
v_lshl_or_b32 v8, v9, 4, v8
v_lshl_or_b32 v8, v12, 9, v8
v_xor_b32 v9, 32, v8
v_add_u32 v8, s58, v8
v_add_u32 v9, s58, v9
v_add_u32 v3, s58, v3
s_add_u32 s56, s56, s60
v_mov_b32 v14, 0
v_mov_b32 v1, 1
s_mov_b32 s62, 0xbfb8aa3b
s_mov_b32 s63, s62
s_add_u32 s40, s20, 4096
s_addc_u32 s41, s21, 0
s_cmp_eq_u32 s22, 2
s_cselect_b32 s42, 0, 3211264
s_mov_b32 s43, 0x00020000
s_add_u32 s32, s20, 3407872
s_addc_u32 s33, s21, 0
s_cmp_eq_u32 s22, 2
s_cselect_b32 s34, 0, 528384
s_mov_b32 s35, 0x00020000
s_cmp_gt_u32 s48, 11
s_cbranch_scc1 k_g2
v_lshlrev_b32 v12, 4, v12
v_lshl_add_u32 v12, v13, 8, v12
s_mov_b64 s[44:45], s[14:15]
s_mov_b32 s46, 65536
s_mov_b32 m0, s58
s_mov_b32 s57, s60
s_waitcnt vmcnt(8)
s_mov_b64 exec, 1
ds_add_u32 v14, v1 offset:50944
s_mov_b64 exec, -1
s_branch k_g3
k_g2:
v_bfe_i32 v11, v13, 0, 3
v_xor_b32 v12, v12, v11
v_lshlrev_b32 v12, 4, v12
v_xor_b32 v12, s60, v12
v_and_b32 v12, 0xf0, v12
v_lshl_add_u32 v12, v13, 8, v12
s_waitcnt vmcnt(6)
k_g3:
k_spx:
ds_read_b32 v15, v14 offset:50944
s_waitcnt lgkmcnt(0)
v_readfirstlane_b32 s61, v15
s_cmp_lt_u32 s61, 4
s_cbranch_scc1 k_spx
ds_read_b128 v[64:67], v4 offset:0
ds_read_b128 v[68:71], v5 offset:0
ds_read_b128 v[72:75], v6 offset:0
ds_read_b128 v[76:79], v7 offset:0
ds_read_b128 v[80:83], v4 offset:4096
ds_read_b128 v[84:87], v5 offset:4096
ds_read_b128 v[88:91], v6 offset:4096
ds_read_b128 v[92:95], v7 offset:4096
ds_read_b128 v[96:99], v4 offset:8192
ds_read_b128 v[100:103], v5 offset:8192
ds_read_b128 v[104:107], v6 offset:8192
ds_read_b128 v[108:111], v7 offset:8192
s_mov_b32 exec_lo, 0x10001
s_mov_b32 exec_hi, 0x10001
ds_read_b128 v[112:115], v4 offset:12288
ds_read_b128 v[116:119], v5 offset:12288
ds_read_b128 v[120:123], v6 offset:12288
ds_read_b128 v[124:127], v7 offset:12288
s_mov_b64 exec, -1
s_waitcnt vmcnt(6)
ds_read_b64_tr_b16 v[32:33], v8 offset:0
ds_read_b64_tr_b16 v[34:35], v8 offset:256
ds_read_b64_tr_b16 v[36:37], v9 offset:0
ds_read_b64_tr_b16 v[38:39], v9 offset:256
s_waitcnt vmcnt(4)
ds_read_b64_tr_b16 v[40:41], v8 offset:2048
ds_read_b64_tr_b16 v[42:43], v8 offset:2304
ds_read_b64_tr_b16 v[44:45], v9 offset:2048
ds_read_b64_tr_b16 v[46:47], v9 offset:2304
s_waitcnt vmcnt(2)
ds_read_b64_tr_b16 v[48:49], v8 offset:4096
ds_read_b64_tr_b16 v[50:51], v8 offset:4352
ds_read_b64_tr_b16 v[52:53], v9 offset:4096
ds_read_b64_tr_b16 v[54:55], v9 offset:4352
s_waitcnt vmcnt(0)
ds_read_b64_tr_b16 v[56:57], v8 offset:6144
ds_read_b64_tr_b16 v[58:59], v8 offset:6400
ds_read_b64_tr_b16 v[60:61], v9 offset:6144
ds_read_b64_tr_b16 v[62:63], v9 offset:6400
s_waitcnt lgkmcnt(12)
v_mfma_f32_16x16x32_bf16 v[16:19], v[32:35], v[64:67], 0
v_mfma_f32_16x16x32_bf16 v[20:23], v[36:39], v[64:67], 0
v_mfma_f32_16x16x32_bf16 v[24:27], v[32:35], v[80:83], 0
v_mfma_f32_16x16x32_bf16 v[28:31], v[36:39], v[80:83], 0
s_waitcnt lgkmcnt(8)
v_mfma_f32_16x16x32_bf16 v[16:19], v[40:43], v[68:71], v[16:19]
v_mfma_f32_16x16x32_bf16 v[20:23], v[44:47], v[68:71], v[20:23]
v_mfma_f32_16x16x32_bf16 v[24:27], v[40:43], v[84:87], v[24:27]
v_mfma_f32_16x16x32_bf16 v[28:31], v[44:47], v[84:87], v[28:31]
s_waitcnt lgkmcnt(4)
v_mfma_f32_16x16x32_bf16 v[16:19], v[48:51], v[72:75], v[16:19]
v_mfma_f32_16x16x32_bf16 v[20:23], v[52:55], v[72:75], v[20:23]
v_mfma_f32_16x16x32_bf16 v[24:27], v[48:51], v[88:91], v[24:27]
v_mfma_f32_16x16x32_bf16 v[28:31], v[52:55], v[88:91], v[28:31]
s_waitcnt lgkmcnt(0)
v_mfma_f32_16x16x32_bf16 v[16:19], v[56:59], v[76:79], v[16:19]
v_mfma_f32_16x16x32_bf16 v[20:23], v[60:63], v[76:79], v[20:23]
v_mfma_f32_16x16x32_bf16 v[24:27], v[56:59], v[92:95], v[24:27]
v_mfma_f32_16x16x32_bf16 v[28:31], v[60:63], v[92:95], v[28:31]
s_cmp_gt_u32 s48, 11
s_cbranch_scc1 k_gq
v_mfma_f32_16x16x32_bf16 v[64:67], v[32:35], v[96:99], 0
v_mfma_f32_16x16x32_bf16 v[68:71], v[36:39], v[96:99], 0
v_mfma_f32_16x16x32_bf16 v[72:75], v[32:35], v[112:115], 0
v_mfma_f32_16x16x32_bf16 v[76:79], v[36:39], v[112:115], 0
v_mfma_f32_16x16x32_bf16 v[64:67], v[40:43], v[100:103], v[64:67]
v_pk_mul_f32 v[16:17], v[16:17], s[62:63]
v_mfma_f32_16x16x32_bf16 v[68:71], v[44:47], v[100:103], v[68:71]
v_pk_mul_f32 v[18:19], v[18:19], s[62:63]
v_mfma_f32_16x16x32_bf16 v[72:75], v[40:43], v[116:119], v[72:75]
v_pk_mul_f32 v[20:21], v[20:21], s[62:63]
v_pk_mul_f32 v[22:23], v[22:23], s[62:63]
v_mfma_f32_16x16x32_bf16 v[76:79], v[44:47], v[116:119], v[76:79]
v_pk_mul_f32 v[24:25], v[24:25], s[62:63]
v_mfma_f32_16x16x32_bf16 v[64:67], v[48:51], v[104:107], v[64:67]
v_pk_mul_f32 v[26:27], v[26:27], s[62:63]
v_mfma_f32_16x16x32_bf16 v[68:71], v[52:55], v[104:107], v[68:71]
v_pk_mul_f32 v[28:29], v[28:29], s[62:63]
v_pk_mul_f32 v[30:31], v[30:31], s[62:63]
v_mfma_f32_16x16x32_bf16 v[72:75], v[48:51], v[120:123], v[72:75]
v_cvt_pk_bf16_f32 v80, v16, v17
v_mfma_f32_16x16x32_bf16 v[76:79], v[52:55], v[120:123], v[76:79]
v_cvt_pk_bf16_f32 v81, v18, v19
v_mfma_f32_16x16x32_bf16 v[64:67], v[56:59], v[108:111], v[64:67]
v_cvt_pk_bf16_f32 v82, v20, v21
v_cvt_pk_bf16_f32 v83, v22, v23
v_mfma_f32_16x16x32_bf16 v[68:71], v[60:63], v[108:111], v[68:71]
v_cvt_pk_bf16_f32 v84, v24, v25
v_mfma_f32_16x16x32_bf16 v[72:75], v[56:59], v[124:127], v[72:75]
v_cvt_pk_bf16_f32 v85, v26, v27
v_mfma_f32_16x16x32_bf16 v[76:79], v[60:63], v[124:127], v[76:79]
v_cvt_pk_bf16_f32 v86, v28, v29
v_cvt_pk_bf16_f32 v87, v30, v31
buffer_store_dwordx4 v[80:83], v12, s[40:43], s56 offen sc0 sc1
s_add_u32 s56, s56, 4096
buffer_store_dwordx4 v[84:87], v12, s[40:43], s56 offen sc0 sc1
s_add_u32 s56, s56, 4096
v_pk_mul_f32 v[64:65], v[64:65], s[62:63]
v_pk_mul_f32 v[66:67], v[66:67], s[62:63]
v_pk_mul_f32 v[68:69], v[68:69], s[62:63]
v_pk_mul_f32 v[70:71], v[70:71], s[62:63]
v_pk_mul_f32 v[72:73], v[72:73], s[62:63]
v_pk_mul_f32 v[74:75], v[74:75], s[62:63]
v_pk_mul_f32 v[76:77], v[76:77], s[62:63]
v_pk_mul_f32 v[78:79], v[78:79], s[62:63]
v_cvt_pk_bf16_f32 v88, v64, v65
v_cvt_pk_bf16_f32 v89, v66, v67
v_cvt_pk_bf16_f32 v90, v68, v69
v_cvt_pk_bf16_f32 v91, v70, v71
v_cvt_pk_bf16_f32 v92, v72, v73
v_cvt_pk_bf16_f32 v93, v74, v75
v_cvt_pk_bf16_f32 v94, v76, v77
v_cvt_pk_bf16_f32 v95, v78, v79
buffer_store_dwordx4 v[88:91], v12, s[40:43], s56 offen sc0 sc1
s_add_u32 s56, s56, 4096
s_mov_b32 exec_lo, 0x10001
s_mov_b32 exec_hi, 0x10001
buffer_store_dwordx4 v[92:95], v12, s[40:43], s56 offen sc0 sc1
s_mov_b64 exec, 1
ds_add_u32 v14, v1 offset:50944
s_mov_b32 exec_lo, 0x10001
s_mov_b32 exec_hi, 0x10001
v_max3_f32 v16, |v16|, |v72|, |v73|
v_max3_f32 v16, |v16|, |v74|, |v75|
v_max3_f32 v16, |v16|, |v76|, |v77|
v_max3_f32 v16, |v16|, |v78|, |v79|
s_mov_b64 exec, -1
v_max3_f32 v13, |v16|, |v17|, |v18|
v_max3_f32 v13, v13, |v19|, |v20|
v_max3_f32 v13, v13, |v21|, |v22|
v_max3_f32 v13, v13, |v23|, |v24|
v_max3_f32 v13, v13, |v25|, |v26|
v_max3_f32 v13, v13, |v27|, |v28|
v_max3_f32 v13, v13, |v29|, |v30|
v_max3_f32 v13, v13, |v31|, |v64|
v_max3_f32 v13, v13, |v65|, |v66|
v_max3_f32 v13, v13, |v67|, |v68|
v_max3_f32 v13, v13, |v69|, |v70|
v_max_f32 v13, v13, |v71|
v_lshrrev_b32 v13, 16, v13
v_add_u32 v13, 1, v13
v_mov_b32 v2, v10
ds_read_b64 v[10:11], v14 offset:51408
v_max_u32_dpp v13, v13, v13 row_shr:1
ds_read_b128 v[64:67], v4 offset:0
ds_read_b128 v[68:71], v5 offset:0
v_max_u32_dpp v13, v13, v13 row_shr:2
ds_read_b128 v[72:75], v6 offset:0
ds_read_b128 v[76:79], v7 offset:0
v_max_u32_dpp v13, v13, v13 row_shr:4
ds_read_b128 v[80:83], v4 offset:4096
ds_read_b128 v[84:87], v5 offset:4096
v_max_u32_dpp v13, v13, v13 row_shr:8
ds_read_b128 v[88:91], v6 offset:4096
ds_read_b128 v[92:95], v7 offset:4096
v_max_u32_dpp v13, v13, v13 row_bcast:15 row_mask:0xa
s_nop 1
v_max_u32_dpp v13, v13, v13 row_bcast:31 row_mask:0xc
s_lshl_b32 s56, s23, 4
s_add_u32 s56, s56, 524288
s_mov_b32 exec_lo, 0
s_mov_b32 exec_hi, 0x80000000
ds_max_u32 v14, v13 offset:51444
k_non:
s_waitcnt lgkmcnt(0)
v_readfirstlane_b32 s54, v10
v_readfirstlane_b32 s55, v11
s_cmp_eq_u32 s54, 0
s_cbranch_scc1 k_non2
s_lshr_b64 s[60:61], s[54:55], 5
s_lshl_b32 s59, s54, 27
v_mov_b32 v13, s60
s_waitcnt vmcnt(0)
ds_add_rtn_u32 v15, v14, v1 offset:51448
ds_read_b32 v12, v14 offset:51444
s_waitcnt lgkmcnt(0)
v_readfirstlane_b32 s57, v15
v_or_b32 v12, s59, v12
s_cmp_eq_u32 s57, 3
s_cselect_b32 s56, s56, 528384
buffer_store_dwordx2 v[12:13], off, s[32:35], s56 sc0 sc1
s_mov_b64 exec, -1
s_setprio 1
s_and_b32 s57, s48, 3
s_lshl_b32 s57, s57, 6
v_mov_b32 v10, v2
buffer_load_dwordx4 v10, s[44:47], s57 offen offset:0 lds
s_add_u32 s57, s57, 3072
buffer_load_dwordx4 v10, s[44:47], s57 offen offset:1024 lds
s_add_u32 s57, s57, 3072
buffer_load_dwordx4 v10, s[44:47], s57 offen offset:2048 lds
s_add_u32 s57, s57, 3072
buffer_load_dwordx4 v10, s[44:47], s57 offen offset:3072 lds
s_add_u32 m0, m0, 4096
s_add_u32 s57, s57, 7168
buffer_load_dwordx4 v10, s[44:47], s57 offen offset:0 lds
s_add_u32 s57, s57, 3072
buffer_load_dwordx4 v10, s[44:47], s57 offen offset:1024 lds
s_add_u32 s57, s57, 3072
buffer_load_dwordx4 v10, s[44:47], s57 offen offset:2048 lds
s_add_u32 s57, s57, 3072
buffer_load_dwordx4 v10, s[44:47], s57 offen offset:3072 lds
s_waitcnt vmcnt(6)
ds_read_b64_tr_b16 v[32:33], v8 offset:0
ds_read_b64_tr_b16 v[34:35], v8 offset:256
ds_read_b64_tr_b16 v[36:37], v9 offset:0
ds_read_b64_tr_b16 v[38:39], v9 offset:256
s_waitcnt vmcnt(4)
ds_read_b64_tr_b16 v[40:41], v8 offset:2048
ds_read_b64_tr_b16 v[42:43], v8 offset:2304
ds_read_b64_tr_b16 v[44:45], v9 offset:2048
ds_read_b64_tr_b16 v[46:47], v9 offset:2304
s_waitcnt vmcnt(2)
ds_read_b64_tr_b16 v[48:49], v8 offset:4096
ds_read_b64_tr_b16 v[50:51], v8 offset:4352
ds_read_b64_tr_b16 v[52:53], v9 offset:4096
ds_read_b64_tr_b16 v[54:55], v9 offset:4352
s_waitcnt vmcnt(0)
ds_read_b64_tr_b16 v[56:57], v8 offset:6144
ds_read_b64_tr_b16 v[58:59], v8 offset:6400
ds_read_b64_tr_b16 v[60:61], v9 offset:6144
ds_read_b64_tr_b16 v[62:63], v9 offset:6400
s_waitcnt lgkmcnt(12)
v_mfma_f32_16x16x32_bf16 v[16:19], v[32:35], v[96:99], 0
v_mfma_f32_16x16x32_bf16 v[20:23], v[36:39], v[96:99], 0
v_mfma_f32_16x16x32_bf16 v[24:27], v[32:35], v[112:115], 0
v_mfma_f32_16x16x32_bf16 v[28:31], v[36:39], v[112:115], 0
s_waitcnt lgkmcnt(8)
v_mfma_f32_16x16x32_bf16 v[16:19], v[40:43], v[100:103], v[16:19]
v_mfma_f32_16x16x32_bf16 v[20:23], v[44:47], v[100:103], v[20:23]
v_mfma_f32_16x16x32_bf16 v[24:27], v[40:43], v[116:119], v[24:27]
v_mfma_f32_16x16x32_bf16 v[28:31], v[44:47], v[116:119], v[28:31]
s_waitcnt lgkmcnt(4)
v_mfma_f32_16x16x32_bf16 v[16:19], v[48:51], v[104:107], v[16:19]
v_mfma_f32_16x16x32_bf16 v[20:23], v[52:55], v[104:107], v[20:23]
v_mfma_f32_16x16x32_bf16 v[24:27], v[48:51], v[120:123], v[24:27]
v_mfma_f32_16x16x32_bf16 v[28:31], v[52:55], v[120:123], v[28:31]
s_waitcnt lgkmcnt(0)
v_mfma_f32_16x16x32_bf16 v[16:19], v[56:59], v[108:111], v[16:19]
v_mfma_f32_16x16x32_bf16 v[20:23], v[60:63], v[108:111], v[20:23]
v_mfma_f32_16x16x32_bf16 v[24:27], v[56:59], v[124:127], v[24:27]
v_mfma_f32_16x16x32_bf16 v[28:31], v[60:63], v[124:127], v[28:31]
v_mfma_f32_16x16x32_bf16 v[96:99], v[32:35], v[64:67], 0
v_mfma_f32_16x16x32_bf16 v[100:103], v[36:39], v[64:67], 0
v_mfma_f32_16x16x32_bf16 v[104:107], v[32:35], v[80:83], 0
v_mfma_f32_16x16x32_bf16 v[108:111], v[36:39], v[80:83], 0
v_mfma_f32_16x16x32_bf16 v[96:99], v[40:43], v[68:71], v[96:99]
v_mfma_f32_16x16x32_bf16 v[100:103], v[44:47], v[68:71], v[100:103]
ds_write_b128 v3, v[16:19] offset:4096
v_mfma_f32_16x16x32_bf16 v[104:107], v[40:43], v[84:87], v[104:107]
v_mfma_f32_16x16x32_bf16 v[108:111], v[44:47], v[84:87], v[108:111]
v_mfma_f32_16x16x32_bf16 v[96:99], v[48:51], v[72:75], v[96:99]
ds_write_b128 v3, v[20:23] offset:5120
v_mfma_f32_16x16x32_bf16 v[100:103], v[52:55], v[72:75], v[100:103]
v_mfma_f32_16x16x32_bf16 v[104:107], v[48:51], v[88:91], v[104:107]
v_mfma_f32_16x16x32_bf16 v[108:111], v[52:55], v[88:91], v[108:111]
ds_write_b128 v3, v[24:27] offset:6144
v_mfma_f32_16x16x32_bf16 v[96:99], v[56:59], v[76:79], v[96:99]
v_mfma_f32_16x16x32_bf16 v[100:103], v[60:63], v[76:79], v[100:103]
v_mfma_f32_16x16x32_bf16 v[104:107], v[56:59], v[92:95], v[104:107]
ds_write_b128 v3, v[28:31] offset:7168
v_mfma_f32_16x16x32_bf16 v[108:111], v[60:63], v[92:95], v[108:111]
s_nop 3
ds_write_b128 v3, v[96:99] offset:0
ds_write_b128 v3, v[100:103] offset:1024
ds_write_b128 v3, v[104:107] offset:2048
s_nop 0
ds_write_b128 v3, v[108:111] offset:3072
s_branch k_setup
k_gq:
s_add_u32 s57, s3, 12544
v_mov_b64 v[4:5], 0
v_mov_b32 v6, s57
v_mov_b32 v7, 0
v_mfma_f32_16x16x32_bf16 v[64:67], v[32:35], v[96:99], 0
ds_write_b128 v3, v[4:7] offset:0
v_mfma_f32_16x16x32_bf16 v[68:71], v[36:39], v[96:99], 0
ds_write_b128 v3, v[4:7] offset:1024
v_mfma_f32_16x16x32_bf16 v[72:75], v[32:35], v[112:115], 0
ds_write_b128 v3, v[4:7] offset:2048
v_mfma_f32_16x16x32_bf16 v[76:79], v[36:39], v[112:115], 0
ds_write_b128 v3, v[4:7] offset:3072
v_mfma_f32_16x16x32_bf16 v[64:67], v[40:43], v[100:103], v[64:67]
ds_write_b128 v3, v[4:7] offset:4096
v_mfma_f32_16x16x32_bf16 v[68:71], v[44:47], v[100:103], v[68:71]
ds_write_b128 v3, v[4:7] offset:5120
v_mfma_f32_16x16x32_bf16 v[72:75], v[40:43], v[116:119], v[72:75]
ds_write_b128 v3, v[4:7] offset:6144
v_mfma_f32_16x16x32_bf16 v[76:79], v[44:47], v[116:119], v[76:79]
ds_write_b128 v3, v[4:7] offset:7168
v_mfma_f32_16x16x32_bf16 v[64:67], v[48:51], v[104:107], v[64:67]
v_pk_mul_f32 v[16:17], v[16:17], s[62:63]
s_mov_b64 exec, 1
ds_add_u32 v14, v1 offset:50948
s_mov_b64 exec, -1
v_mfma_f32_16x16x32_bf16 v[68:71], v[52:55], v[104:107], v[68:71]
v_pk_mul_f32 v[18:19], v[18:19], s[62:63]
v_mfma_f32_16x16x32_bf16 v[72:75], v[48:51], v[120:123], v[72:75]
v_pk_mul_f32 v[20:21], v[20:21], s[62:63]
v_mfma_f32_16x16x32_bf16 v[76:79], v[52:55], v[120:123], v[76:79]
v_pk_mul_f32 v[22:23], v[22:23], s[62:63]
v_mfma_f32_16x16x32_bf16 v[64:67], v[56:59], v[108:111], v[64:67]
v_pk_mul_f32 v[24:25], v[24:25], s[62:63]
v_mfma_f32_16x16x32_bf16 v[68:71], v[60:63], v[108:111], v[68:71]
v_pk_mul_f32 v[26:27], v[26:27], s[62:63]
v_mfma_f32_16x16x32_bf16 v[72:75], v[56:59], v[124:127], v[72:75]
v_pk_mul_f32 v[28:29], v[28:29], s[62:63]
v_mfma_f32_16x16x32_bf16 v[76:79], v[60:63], v[124:127], v[76:79]
v_pk_mul_f32 v[30:31], v[30:31], s[62:63]
ds_write_b128 v12, v[16:19] offset:0
ds_write_b128 v12, v[20:23] offset:12800
ds_write_b128 v12, v[24:27] offset:4096
ds_write_b128 v12, v[28:31] offset:16896
v_pk_mul_f32 v[64:65], v[64:65], s[62:63]
v_pk_mul_f32 v[66:67], v[66:67], s[62:63]
v_pk_mul_f32 v[68:69], v[68:69], s[62:63]
v_pk_mul_f32 v[70:71], v[70:71], s[62:63]
v_pk_mul_f32 v[72:73], v[72:73], s[62:63]
v_pk_mul_f32 v[74:75], v[74:75], s[62:63]
v_pk_mul_f32 v[76:77], v[76:77], s[62:63]
v_pk_mul_f32 v[78:79], v[78:79], s[62:63]
ds_write_b128 v12, v[64:67] offset:8192
ds_write_b128 v12, v[68:71] offset:20992
s_mov_b32 exec_lo, 0x10001
s_mov_b32 exec_hi, 0x10001
ds_write_b128 v12, v[72:75] offset:12288
ds_write_b128 v12, v[76:79] offset:25088
v_max3_f32 v16, |v16|, |v72|, |v73|
v_max3_f32 v16, |v16|, |v74|, |v75|
v_max3_f32 v16, |v16|, |v76|, |v77|
v_max3_f32 v16, |v16|, |v78|, |v79|
s_mov_b64 exec, -1
v_max3_f32 v13, |v16|, |v17|, |v18|
v_max3_f32 v13, v13, |v19|, |v20|
v_max3_f32 v13, v13, |v21|, |v22|
v_max3_f32 v13, v13, |v23|, |v24|
v_max3_f32 v13, v13, |v25|, |v26|
v_max3_f32 v13, v13, |v27|, |v28|
v_max3_f32 v13, v13, |v29|, |v30|
v_max3_f32 v13, v13, |v31|, |v64|
v_max3_f32 v13, v13, |v65|, |v66|
v_max3_f32 v13, v13, |v67|, |v68|
v_max3_f32 v13, v13, |v69|, |v70|
v_max_f32 v13, v13, |v71|
v_lshrrev_b32 v13, 16, v13
v_add_u32 v13, 1, v13
s_nop 1
v_max_u32_dpp v13, v13, v13 row_shr:1
s_nop 1
v_max_u32_dpp v13, v13, v13 row_shr:2
s_nop 1
v_max_u32_dpp v13, v13, v13 row_shr:4
s_nop 1
v_max_u32_dpp v13, v13, v13 row_shr:8
s_nop 1
v_max_u32_dpp v13, v13, v13 row_bcast:15 row_mask:0xa
s_nop 1
v_max_u32_dpp v13, v13, v13 row_bcast:31 row_mask:0xc
s_mov_b32 exec_lo, 0
s_mov_b32 exec_hi, 0x80000000
ds_max_u32 v14, v13 offset:51428
s_mov_b64 exec, -1
k_setup:
s_cmp_eq_u32 s22, 1
s_cbranch_scc1 k_redo
s_add_u32 s28, s20, 4194304
s_addc_u32 s29, s21, 0
s_mov_b32 s30, 13107200
s_mov_b32 s31, 0x00020000
s_and_b32 s55, s55, 31
k_round:
v_and_b32 v6, 3, v0
v_lshrrev_b32 v4, 2, v0
s_mov_b32 s56, 51200
v_mul_u32_u24 v4, s56, v4
v_lshl_add_u32 v4, v6, 4, v4
v_mov_b32 v114, 0
s_movk_i32 s53, 400
s_mov_b32 s59, 6553600
s_cmp_gt_u32 s48, 7
s_cbranch_scc1 k_common
s_cmp_lg_u32 s50, 0
s_cbranch_scc1 k_cw
v_mov_b32 v67, s54
v_mov_b32 v71, s54
v_mov_b32 v75, s54
v_mov_b32 v79, s54
v_mov_b32 v83, s54
v_mov_b32 v87, s54
v_mov_b32 v91, s54
v_mov_b32 v95, s54
v_mov_b32 v99, s54
v_mov_b32 v103, s54
v_mov_b32 v107, s54
v_mov_b32 v111, s54
k_pw:
ds_read_b32 v52, v114 offset:50944
s_waitcnt lgkmcnt(0)
v_readfirstlane_b32 s56, v52
s_cmp_lt_u32 s56, 8
s_cbranch_scc1 k_pw
buffer_load_dwordx2 v[116:117], v3, s[32:35], s52 offen sc0 sc1
buffer_load_dwordx2 v[118:119], v3, s[32:35], s49 offen sc0 sc1
s_waitcnt vmcnt(0)
k_poll1:
v_lshrrev_b64 v[52:53], 27, v[116:117]
v_lshrrev_b64 v[54:55], 27, v[118:119]
v_cmp_ne_u64 s[12:13], s[54:55], v[52:53]
v_cmp_ne_u64 vcc, s[54:55], v[54:55]
v_bfe_u32 v50, v116, 16, 11
v_bfe_u32 v51, v118, 16, 11
v_add_u32_sdwa v48, v116, v4 dst_sel:DWORD dst_unused:UNUSED_PAD src0_sel:WORD_0 src1_sel:DWORD
v_add_u32_sdwa v49, v118, v4 dst_sel:DWORD dst_unused:UNUSED_PAD src0_sel:WORD_0 src1_sel:DWORD
v_sub_u32 v50, v50, v6
v_sub_u32 v51, v51, v6
s_or_b64 s[10:11], s[12:13], vcc
s_cbranch_scc1 k_poll2
s_waitcnt vmcnt(0)
k_rw:
ds_read_b32 v52, v114 offset:51448
s_waitcnt lgkmcnt(0)
v_readfirstlane_b32 s56, v52
s_cmp_lt_u32 s56, 4
s_cbranch_scc1 k_rw
v_cmp_lt_i32 s[4:5], 0, v50
v_cmp_lt_i32 s[98:99], 0, v51
v_cmp_lt_i32 s[6:7], 4, v50
v_cmp_lt_i32 s[100:101], 4, v51
v_cmp_lt_i32 s[8:9], 8, v50
v_cmp_lt_i32 s[40:41], 8, v51
v_cmp_lt_i32 s[10:11], 12, v50
v_cmp_lt_i32 s[42:43], 12, v51
s_mov_b64 exec, s[4:5]
buffer_load_dwordx4 v[64:67], v48, s[28:31], 0 offen offset:0 sc0 sc1
s_mov_b64 exec, s[98:99]
buffer_load_dwordx4 v[88:91], v49, s[28:31], s59 offen offset:0 sc0 sc1
s_mov_b64 exec, s[6:7]
buffer_load_dwordx4 v[68:71], v48, s[28:31], 0 offen offset:64 sc0 sc1
s_mov_b64 exec, s[100:101]
buffer_load_dwordx4 v[92:95], v49, s[28:31], s59 offen offset:64 sc0 sc1
s_mov_b64 exec, s[8:9]
buffer_load_dwordx4 v[72:75], v48, s[28:31], 0 offen offset:128 sc0 sc1
s_mov_b64 exec, s[40:41]
buffer_load_dwordx4 v[96:99], v49, s[28:31], s59 offen offset:128 sc0 sc1
s_or_b64 vcc, s[10:11], s[42:43]
s_cbranch_scc1 k_ld3
k_ld3r:
s_mov_b64 exec, -1
k_common:
v_lshlrev_b32 v2, 4, v0
s_add_u32 s24, s20, 4096
s_addc_u32 s25, s21, 0
s_or_b32 s25, s25, 16777216
s_mov_b32 s26, 12800
s_mov_b32 s27, 0x00020000
s_mov_b64 s[36:37], s[14:15]
s_mov_b32 s38, 65536
s_mov_b32 s62, 0x22221111
s_mov_b32 s63, 0x88884444
s_movk_i32 s56, 784
v_cmp_gt_u32 s[60:61], s56, v0
v_and_b32 v7, 0xf0, v2
v_mov_b32 v9, v7
v_mov_b32 v11, v7
v_mov_b32 v13, v7
v_and_b32 v116, 0x3f0, v2
v_and_b32 v53, 0x30, v0
v_lshlrev_b32 v125, 1, v53
v_xor_b32 v125, v125, v116
v_lshrrev_b32 v52, 4, v0
v_bfe_i32 v120, v52, 0, 3
v_lshlrev_b32 v120, 4, v120
v_xor_b32 v120, v120, v7
v_and_b32 v120, 0xf0, v120
v_lshl_add_u32 v120, v52, 8, v120
v_and_b32 v121, 0xf0, v0
v_xor_b32 v121, v121, v2
v_and_b32 v122, 0x1c, v0
v_lshlrev_b32 v122, 3, v122
v_lshl_or_b32 v122, v6, 3, v122
s_and_b32 s56, s48, 3
s_lshl_b32 s58, s56, 13
s_lshl_b32 s56, s56, 6
v_xor_b32 v122, s56, v122
v_and_b32 v52, 0x3c, v0
v_lshl_or_b32 v122, v52, 6, v122
v_add_u32 v122, 52480, v122
s_lshr_b32 s57, s48, 2
s_lshl_b32 s57, s57, 11
s_add_u32 s58, s58, s57
s_lshl_b32 s57, s57, 1
v_lshl_add_u32 v124, v7, 4, s57
v_xor_b32 v123, v53, v7
v_add_u32 v123, v123, v124
v_and_b32 v52, 16, v0
v_lshl_add_u32 v124, v52, 1, v124
v_bfe_u32 v52, v0, 5, 1
v_lshl_add_u32 v124, v52, 4, v124
v_add_u32 v124, s56, v124
s_cmp_gt_u32 s48, 11
s_cbranch_scc0 k_r3s
v_lshl_add_u32 v124, v6, 1, s57
v_and_b32 v52, 4, v0
v_lshl_add_u32 v124, v52, 3, v124
v_lshrrev_b32 v52, 1, v53
v_add3_u32 v124, v124, v52, s56
k_r3s:
v_lshlrev_b32 v52, 4, v6
v_mov_b32 v16, 0x3f80
v_mov_b32 v17, 0
v_mov_b64 v[14:15], 0
s_mov_b32 exec_lo, 0x00f0000f
s_mov_b32 exec_hi, 0xf0000f00
v_lshlrev_b64 v[14:15], v52, v[16:17]
s_mov_b64 exec, -1
v_mov_b64 v[18:19], v[14:15]
v_mov_b64 v[16:17], 0
v_mov_b64 v[22:23], v[14:15]
v_mov_b64 v[20:21], 0
v_mov_b64 v[26:27], v[14:15]
v_mov_b64 v[24:25], 0
v_mov_b64 v[30:31], v[14:15]
v_mov_b64 v[28:29], 0
s_add_u32 m0, s58, 52480
v_add_u32 v115, m0, v116
s_add_u32 s58, s58, 32768
v_lshrrev_b32 v12, 2, v116
v_add_u32 v116, 97792, v116
s_movk_i32 s56, 288
v_mov_b32 v112, 108160
v_mad_u32_u24 v112, v12, s56, v112
s_movk_i32 s56, 204
v_cmp_gt_u32 vcc, s56, v12
s_nop 1
v_cndmask_b32 v112, -1, v112, vcc
s_lshl_b32 s56, s48, 5
s_add_u32 s56, s56, 98816
v_and_b32 v5, 0xc, v0
v_lshl_add_u32 v5, v5, 1, s56
v_bfe_u32 v0, v0, 4, 2
v_lshl_add_u32 v0, v0, 3, s56
v_mov_b32 v1, 16
s_cmp_gt_u32 s48, 7
s_cbranch_scc1 k_nc
s_cmp_lg_u32 s50, 0
s_cbranch_scc1 k_slowd
k_chk:
s_waitcnt vmcnt(0)
v_bitop3_b32 v52, v67, v71, s54 bitop3:0x7e
v_bitop3_b32 v53, v75, v79, s54 bitop3:0x7e
v_bitop3_b32 v54, v83, v87, s54 bitop3:0x7e
v_bitop3_b32 v55, v91, v95, s54 bitop3:0x7e
v_bitop3_b32 v56, v99, v103, s54 bitop3:0x7e
v_bitop3_b32 v57, v107, v111, s54 bitop3:0x7e
v_or3_b32 v52, v52, v53, v54
v_or3_b32 v55, v55, v56, v57
v_or_b32 v53, v52, v55
v_cmp_ne_u32 vcc, 0, v53
s_cbranch_vccnz k_retry
ds_read_b32 v52, v114 offset:50948
s_mov_b64 exec, s[4:5]
v_lshlrev_b32_sdwa v32, 2, v66 dst_sel:DWORD dst_unused:UNUSED_PAD src0_sel:DWORD src1_sel:BYTE_3
ds_add_rtn_u32 v67, v32, v1 offset:51200
s_mov_b64 exec, s[98:99]
v_lshlrev_b32_sdwa v38, 2, v90 dst_sel:DWORD dst_unused:UNUSED_PAD src0_sel:DWORD src1_sel:BYTE_3
ds_add_rtn_u32 v91, v38, v1 offset:51200
s_mov_b64 exec, s[6:7]
v_lshlrev_b32_sdwa v33, 2, v70 dst_sel:DWORD dst_unused:UNUSED_PAD src0_sel:DWORD src1_sel:BYTE_3
ds_add_rtn_u32 v71, v33, v1 offset:51200
s_mov_b64 exec, s[100:101]
v_lshlrev_b32_sdwa v39, 2, v94 dst_sel:DWORD dst_unused:UNUSED_PAD src0_sel:DWORD src1_sel:BYTE_3
ds_add_rtn_u32 v95, v39, v1 offset:51200
s_mov_b64 exec, s[8:9]
v_lshlrev_b32_sdwa v34, 2, v74 dst_sel:DWORD dst_unused:UNUSED_PAD src0_sel:DWORD src1_sel:BYTE_3
ds_add_rtn_u32 v75, v34, v1 offset:51200
s_mov_b64 exec, s[40:41]
v_lshlrev_b32_sdwa v40, 2, v98 dst_sel:DWORD dst_unused:UNUSED_PAD src0_sel:DWORD src1_sel:BYTE_3
ds_add_rtn_u32 v99, v40, v1 offset:51200
s_or_b64 vcc, s[10:11], s[42:43]
s_cbranch_scc1 k_rk3
k_rk3r:
s_waitcnt lgkmcnt(0)
v_readlane_b32 s57, v52, 0
s_mov_b32 s56, 0
s_cmp_lt_u32 s57, 4
s_cbranch_scc1 k_pfq
s_mov_b64 exec, s[4:5]
v_min_u32 v67, 163824, v67
v_and_b32 v32, 63, v67
ds_write_b96 v67, v[64:66]
v_cmp_eq_u32 s[4:5], 0, v32
v_mov_b32 v32, s56
s_nop 0
v_mbcnt_lo_u32_b32 v32, s4, v32
v_mbcnt_hi_u32_b32 v32, s5, v32
s_bcnt1_i32_b64 s57, s[4:5]
s_add_u32 s56, s56, s57
s_mov_b64 exec, s[98:99]
v_min_u32 v91, 163824, v91
v_and_b32 v38, 63, v91
ds_write_b96 v91, v[88:90]
v_cmp_eq_u32 s[98:99], 0, v38
v_mov_b32 v38, s56
s_nop 0
v_mbcnt_lo_u32_b32 v38, s98, v38
v_mbcnt_hi_u32_b32 v38, s99, v38
s_bcnt1_i32_b64 s57, s[98:99]
s_add_u32 s56, s56, s57
s_mov_b64 exec, s[6:7]
v_min_u32 v71, 163824, v71
v_and_b32 v33, 63, v71
ds_write_b96 v71, v[68:70]
v_cmp_eq_u32 s[6:7], 0, v33
v_mov_b32 v33, s56
s_nop 0
v_mbcnt_lo_u32_b32 v33, s6, v33
v_mbcnt_hi_u32_b32 v33, s7, v33
s_bcnt1_i32_b64 s57, s[6:7]
s_add_u32 s56, s56, s57
s_mov_b64 exec, s[100:101]
v_min_u32 v95, 163824, v95
v_and_b32 v39, 63, v95
ds_write_b96 v95, v[92:94]
v_cmp_eq_u32 s[100:101], 0, v39
v_mov_b32 v39, s56
s_nop 0
v_mbcnt_lo_u32_b32 v39, s100, v39
v_mbcnt_hi_u32_b32 v39, s101, v39
s_bcnt1_i32_b64 s57, s[100:101]
s_add_u32 s56, s56, s57
s_mov_b64 exec, s[8:9]
v_min_u32 v75, 163824, v75
v_and_b32 v34, 63, v75
ds_write_b96 v75, v[72:74]
v_cmp_eq_u32 s[8:9], 0, v34
v_mov_b32 v34, s56
s_nop 0
v_mbcnt_lo_u32_b32 v34, s8, v34
v_mbcnt_hi_u32_b32 v34, s9, v34
s_bcnt1_i32_b64 s57, s[8:9]
s_add_u32 s56, s56, s57
s_mov_b64 exec, s[40:41]
v_min_u32 v99, 163824, v99
v_and_b32 v40, 63, v99
ds_write_b96 v99, v[96:98]
v_cmp_eq_u32 s[40:41], 0, v40
v_mov_b32 v40, s56
s_nop 0
v_mbcnt_lo_u32_b32 v40, s40, v40
v_mbcnt_hi_u32_b32 v40, s41, v40
s_bcnt1_i32_b64 s57, s[40:41]
s_add_u32 s56, s56, s57
s_cbranch_vccnz k_pl3
s_lshl_b32 s56, s56, 3
s_mov_b64 exec, 1
v_mov_b32 v52, s56
ds_add_rtn_u32 v52, v114, v52 offset:51452
s_waitcnt lgkmcnt(0)
v_readfirstlane_b32 s56, v52
k_pl3r:
s_mov_b64 exec, s[4:5]
s_nop 0
v_lshl_add_u32 v32, v32, 3, s56
ds_write_b64 v32, v[66:67]
s_mov_b64 exec, s[98:99]
v_lshl_add_u32 v38, v38, 3, s56
ds_write_b64 v38, v[90:91]
s_mov_b64 exec, s[6:7]
v_lshl_add_u32 v33, v33, 3, s56
ds_write_b64 v33, v[70:71]
s_mov_b64 exec, s[100:101]
v_lshl_add_u32 v39, v39, 3, s56
ds_write_b64 v39, v[94:95]
s_mov_b64 exec, s[8:9]
v_lshl_add_u32 v34, v34, 3, s56
ds_write_b64 v34, v[74:75]
s_mov_b64 exec, s[40:41]
v_lshl_add_u32 v40, v40, 3, s56
ds_write_b64 v40, v[98:99]
k_ba:
s_mov_b64 exec, -1
v_lshrrev_b32 v97, 8, v120
v_mul_u32_u24 v98, 1152, v97
v_lshlrev_b32 v97, 2, v97
v_xor_b32 v100, 0x80, v125
s_mov_b32 s51, 0
s_waitcnt lgkmcnt(0)
s_barrier
ds_read_b32 v1, v0 offset:4
ds_read_b32 v96, v12 offset:51200
ds_read_b32 v4, v0 offset:516
ds_read_b32 v2, v5 offset:4
ds_read_u16 v3, v0 offset:2
ds_read_b32 v97, v97 offset:51200
s_waitcnt lgkmcnt(5)
ds_read_u16 v6, v1 offset:8
ds_read_u16 v8, v1 offset:24
ds_read_u16 v10, v1 offset:40
ds_read_u16 v12, v1 offset:56
s_waitcnt lgkmcnt(4)
v_mov_b32 v1, v4
v_xor_b32 v3, v3, v7
v_cmp_gt_u32 vcc, v96, v112
v_readlane_b32 s53, v96, 63
v_lshlrev_b32 v99, 16, v96
s_waitcnt lgkmcnt(0)
buffer_load_dwordx4 v[34:37], v[6:7], s[24:27], 0 idxen offen sc0 sc1
s_mov_b64 exec, s[62:63]
ds_read_b64 v[16:17], v2 offset:0
s_mov_b64 exec, -1
ds_read_u16 v6, v1 offset:8
buffer_load_dwordx4 v[42:45], v[8:9], s[24:27], 0 idxen offen sc0 sc1
s_mov_b64 exec, s[62:63]
ds_read_b64 v[20:21], v2 offset:16
s_mov_b64 exec, -1
ds_read_u16 v8, v1 offset:24
buffer_load_dwordx4 v[50:53], v[10:11], s[24:27], 0 idxen offen sc0 sc1
s_mov_b64 exec, s[62:63]
ds_read_b64 v[24:25], v2 offset:32
s_mov_b64 exec, -1
ds_read_u16 v10, v1 offset:40
buffer_load_dwordx4 v[58:61], v[12:13], s[24:27], 0 idxen offen sc0 sc1
s_mov_b64 exec, s[62:63]
ds_read_b64 v[28:29], v2 offset:48
s_mov_b64 exec, -1
ds_read_u16 v12, v1 offset:56
ds_read_b128 v[104:107], v3
ds_read_b128 v[108:111], v3 offset:12800
ds_read_b32 v1, v0 offset:1028
ds_read_b32 v2, v5 offset:516
ds_read_b128 v[38:41], v116
ds_read_b128 v[46:49], v116
ds_read_b128 v[54:57], v116
ds_read_b64 v[62:63], v116
ds_read_b64 v[32:33], v116 offset:8
s_cbranch_vccnz k_abn
k_abnr:
ds_read_b128 v[116:119], v115 offset:1024
ds_read_b128 v[112:115], v115
k_abnr2:
v_readlane_b32 s40, v99, 59
v_readlane_b32 s41, v99, 57
v_readlane_b32 s42, v99, 58
v_readlane_b32 s43, v96, 56
s_add_u32 s53, s53, -98785
s_lshr_b32 s53, s53, 5
v_mov_b32 v99, s40
v_fma_f32 v99, s41, 4.0, v99
v_mov_b32 v96, s42
v_fma_f32 v99, s43, v96, v99
s_sub_u32 s53, s53, s48
s_add_u32 s53, s53, 15
s_lshr_b32 s53, s53, 4
v_readfirstlane_b32 s56, v99
v_sub_u32 v97, v97, v98
v_subrev_u32 v97, 106960, v97
s_sub_u32 s57, s56, 0x3c800000
s_cmp_gt_u32 s57, 91226112
s_cselect_b32 s57, 2, 0
s_or_b32 s50, s50, s57
s_cbranch_scc1 k_pc_x
s_and_b32 s56, s56, 0x7f800000
s_add_u32 s44, s56, 46137344
s_mov_b32 s45, s44
s_add_u32 s46, s56, 1991340568
s_mov_b32 s47, s46
s_sub_u32 s42, 0, s44
s_subb_u32 s43, 0, s44
v_lshrrev_b32 v97, 6, v97
s_mov_b64 exec, s[60:61]
v_mad_u64_u32 v[98:99], vcc, v97, s42, 0
v_mul_lo_u32 v97, v97, s43
v_add_u32 v99, v99, v97
s_waitcnt lgkmcnt(0)
ds_add_u64 v120, v[98:99] offset:25600
ds_add_u64 v120, v[98:99] offset:25608
ds_add_u64 v120, v[98:99] offset:38400
ds_add_u64 v120, v[98:99] offset:38408
s_mov_b64 exec, -1
buffer_load_dwordx4 v125, s[36:39], s58 offen lds
buffer_load_dwordx4 v100, s[36:39], s58 offen offset:1024 lds
s_lshl_b32 s56, 0x10000, s48
v_mov_b32 v126, 0
v_mov_b32 v127, s56
s_cmp_eq_u32 s53, 0
s_cbranch_scc1 k_epi
s_waitcnt vmcnt(5)
v_mfma_f32_16x16x32_bf16 v[64:67], v[16:19], v[32:35], v[104:107]
v_mfma_f32_16x16x32_bf16 v[68:71], v[14:17], v[36:39], v[108:111]
s_setprio 3
s_cmp_eq_u32 s53, 1
s_cbranch_scc1 k_last_f
k_loop_f:
s_waitcnt lgkmcnt(4)
v_mov_b32 v4, v3
ds_read_u16 v3, v0 offset:514
buffer_load_dwordx4 v[34:37], v[6:7], s[24:27], 0 idxen offen sc0 sc1
s_mov_b64 exec, s[62:63]
ds_read_b64 v[16:17], v2 offset:0
s_mov_b64 exec, -1
ds_read_u16 v6, v1 offset:8
v_exp_f32 v96, v64
v_exp_f32 v97, v65
s_waitcnt vmcnt(3)
v_mfma_f32_16x16x32_bf16 v[72:75], v[20:23], v[40:43], v[104:107]
v_exp_f32 v98, v66
v_exp_f32 v99, v67
v_exp_f32 v100, v68
v_mfma_f32_16x16x32_bf16 v[76:79], v[18:21], v[44:47], v[108:111]
v_exp_f32 v101, v69
v_exp_f32 v102, v70
v_exp_f32 v103, v71
v_pk_add_f32 v[88:89], v[96:97], 1.0 op_sel_hi:[1,0]
v_pk_add_f32 v[90:91], v[98:99], 1.0 op_sel_hi:[1,0]
v_pk_add_f32 v[92:93], v[100:101], 1.0 op_sel_hi:[1,0]
v_pk_add_f32 v[94:95], v[102:103], 1.0 op_sel_hi:[1,0]
buffer_load_dwordx4 v[42:45], v[8:9], s[24:27], 0 idxen offen sc0 sc1
s_mov_b64 exec, s[62:63]
ds_read_b64 v[20:21], v2 offset:16
s_mov_b64 exec, -1
ds_read_u16 v8, v1 offset:24
v_exp_f32 v96, v72
v_exp_f32 v97, v73
s_waitcnt vmcnt(3)
v_mfma_f32_16x16x32_bf16 v[80:83], v[24:27], v[48:51], v[104:107]
v_exp_f32 v98, v74
v_exp_f32 v99, v75
v_exp_f32 v100, v76
v_mfma_f32_16x16x32_bf16 v[84:87], v[22:25], v[52:55], v[108:111]
v_exp_f32 v101, v77
v_exp_f32 v102, v78
v_exp_f32 v103, v79
v_pk_fma_f32 v[72:73], v[72:73], v[88:89], v[64:65]
v_pk_fma_f32 v[74:75], v[74:75], v[90:91], v[66:67]
v_pk_fma_f32 v[76:77], v[76:77], v[92:93], v[68:69]
v_pk_fma_f32 v[78:79], v[78:79], v[94:95], v[70:71]
v_pk_fma_f32 v[88:89], v[88:89], v[96:97], v[88:89]
v_pk_fma_f32 v[90:91], v[90:91], v[98:99], v[90:91]
v_pk_fma_f32 v[92:93], v[92:93], v[100:101], v[92:93]
v_pk_fma_f32 v[94:95], v[94:95], v[102:103], v[94:95]
v_pk_fma_f32 v[64:65], v[64:65], v[96:97], v[72:73]
v_pk_fma_f32 v[66:67], v[66:67], v[98:99], v[74:75]
v_pk_fma_f32 v[68:69], v[68:69], v[100:101], v[76:77]
v_pk_fma_f32 v[70:71], v[70:71], v[102:103], v[78:79]
buffer_load_dwordx4 v[50:53], v[10:11], s[24:27], 0 idxen offen sc0 sc1
s_mov_b64 exec, s[62:63]
ds_read_b64 v[24:25], v2 offset:32
s_mov_b64 exec, -1
ds_read_u16 v10, v1 offset:40
v_exp_f32 v96, v80
v_exp_f32 v97, v81
s_waitcnt vmcnt(3) lgkmcnt(6)
v_mfma_f32_16x16x32_bf16 v[72:75], v[28:31], v[56:59], v[104:107]
v_exp_f32 v98, v82
v_exp_f32 v99, v83
v_exp_f32 v100, v84
v_mfma_f32_16x16x32_bf16 v[76:79], v[26:29], v[60:63], v[108:111]
v_exp_f32 v101, v85
v_exp_f32 v102, v86
v_exp_f32 v103, v87
v_xor_b32 v3, v3, v7
ds_read_b128 v[104:107], v3
ds_read_b128 v[108:111], v3 offset:12800
v_pk_fma_f32 v[80:81], v[80:81], v[88:89], v[64:65]
v_pk_fma_f32 v[82:83], v[82:83], v[90:91], v[66:67]
v_pk_fma_f32 v[84:85], v[84:85], v[92:93], v[68:69]
v_pk_fma_f32 v[86:87], v[86:87], v[94:95], v[70:71]
v_pk_fma_f32 v[88:89], v[88:89], v[96:97], v[88:89]
v_pk_fma_f32 v[90:91], v[90:91], v[98:99], v[90:91]
v_pk_fma_f32 v[92:93], v[92:93], v[100:101], v[92:93]
v_pk_fma_f32 v[94:95], v[94:95], v[102:103], v[94:95]
v_pk_fma_f32 v[64:65], v[64:65], v[96:97], v[80:81]
v_pk_fma_f32 v[66:67], v[66:67], v[98:99], v[82:83]
v_pk_fma_f32 v[68:69], v[68:69], v[100:101], v[84:85]
v_pk_fma_f32 v[70:71], v[70:71], v[102:103], v[86:87]
buffer_load_dwordx4 v[58:61], v[12:13], s[24:27], 0 idxen offen sc0 sc1
s_mov_b64 exec, s[62:63]
ds_read_b64 v[28:29], v2 offset:48
s_mov_b64 exec, -1
ds_read_u16 v12, v1 offset:56
ds_read_b32 v1, v0 offset:1540
ds_read_b32 v2, v5 offset:1028
v_add_u32 v0, 0x200, v0
v_add_u32 v5, 0x200, v5
v_exp_f32 v96, v72
v_exp_f32 v97, v73
v_exp_f32 v98, v74
v_exp_f32 v99, v75
v_exp_f32 v100, v76
v_exp_f32 v101, v77
v_exp_f32 v102, v78
v_exp_f32 v103, v79
v_pk_fma_f32 v[72:73], v[72:73], v[88:89], v[64:65]
v_pk_fma_f32 v[74:75], v[74:75], v[90:91], v[66:67]
v_pk_fma_f32 v[76:77], v[76:77], v[92:93], v[68:69]
v_pk_fma_f32 v[78:79], v[78:79], v[94:95], v[70:71]
v_pk_fma_f32 v[88:89], v[88:89], v[96:97], v[88:89]
v_pk_fma_f32 v[90:91], v[90:91], v[98:99], v[90:91]
v_pk_fma_f32 v[92:93], v[92:93], v[100:101], v[92:93]
v_pk_fma_f32 v[94:95], v[94:95], v[102:103], v[94:95]
v_pk_fma_f32 v[64:65], v[64:65], v[96:97], v[72:73]
v_pk_fma_f32 v[66:67], v[66:67], v[98:99], v[74:75]
v_pk_fma_f32 v[68:69], v[68:69], v[100:101], v[76:77]
v_pk_fma_f32 v[70:71], v[70:71], v[102:103], v[78:79]
v_rcp_f32 v88, v88
v_rcp_f32 v89, v89
v_rcp_f32 v90, v90
v_rcp_f32 v91, v91
v_rcp_f32 v92, v92
v_rcp_f32 v93, v93
v_rcp_f32 v94, v94
v_rcp_f32 v95, v95
v_pk_fma_f32 v[88:89], v[64:65], v[88:89], s[44:45]
v_pk_fma_f32 v[90:91], v[66:67], v[90:91], s[44:45]
v_pk_fma_f32 v[92:93], v[68:69], v[92:93], s[44:45]
v_pk_fma_f32 v[94:95], v[70:71], v[94:95], s[44:45]
s_waitcnt vmcnt(3) lgkmcnt(4)
v_mfma_f32_16x16x32_bf16 v[64:67], v[16:19], v[32:35], v[104:107]
v_mfma_f32_16x16x32_bf16 v[68:71], v[14:17], v[36:39], v[108:111]
ds_add_u64 v4, v[88:89] offset:25600
ds_add_u64 v4, v[90:91] offset:25608
ds_add_u64 v4, v[92:93] offset:38400
ds_add_u64 v4, v[94:95] offset:38408
s_sub_u32 s53, s53, 1
s_cmp_gt_u32 s53, 3
s_cbranch_scc1 k_loop_f
s_setprio 2
s_mov_b64 exec, 1
ds_or_b32 v126, v127 offset:51420
s_mov_b64 exec, -1
s_cmp_gt_u32 s53, 2
s_cbranch_scc1 k_loop_f
s_setprio 1
s_cmp_gt_u32 s53, 1
s_cbranch_scc1 k_loop_f
k_last_f:
s_setprio 0
s_waitcnt lgkmcnt(4)
ds_read_b32 v2, v126 offset:51420
s_nop 0
v_exp_f32 v96, v64
v_exp_f32 v97, v65
s_waitcnt vmcnt(2)
v_mfma_f32_16x16x32_bf16 v[72:75], v[20:23], v[40:43], v[104:107]
v_exp_f32 v98, v66
v_exp_f32 v99, v67
v_exp_f32 v100, v68
v_mfma_f32_16x16x32_bf16 v[76:79], v[18:21], v[44:47], v[108:111]
v_exp_f32 v101, v69
v_exp_f32 v102, v70
v_exp_f32 v103, v71
v_pk_add_f32 v[88:89], v[96:97], 1.0 op_sel_hi:[1,0]
v_pk_add_f32 v[90:91], v[98:99], 1.0 op_sel_hi:[1,0]
v_pk_add_f32 v[92:93], v[100:101], 1.0 op_sel_hi:[1,0]
v_pk_add_f32 v[94:95], v[102:103], 1.0 op_sel_hi:[1,0]
s_waitcnt lgkmcnt(0)
v_readfirstlane_b32 s58, v2
v_xor_b32 v1, 32, v122
s_cmp_ge_u32 s58, 0xffff0000
s_cbranch_scc0 k_nh1
ds_read_b64_tr_b16 v[32:33], v122 offset:0
ds_read_b64_tr_b16 v[34:35], v122 offset:4096
ds_read_b64_tr_b16 v[36:37], v1 offset:0
ds_read_b64_tr_b16 v[38:39], v1 offset:4096
ds_read_b64_tr_b16 v[40:41], v122 offset:8192
ds_read_b64_tr_b16 v[42:43], v122 offset:12288
ds_read_b64_tr_b16 v[44:45], v1 offset:8192
ds_read_b64_tr_b16 v[46:47], v1 offset:12288
k_nh1:
v_exp_f32 v96, v72
v_exp_f32 v97, v73
s_waitcnt vmcnt(1)
v_mfma_f32_16x16x32_bf16 v[80:83], v[24:27], v[48:51], v[104:107]
v_exp_f32 v98, v74
v_exp_f32 v99, v75
v_exp_f32 v100, v76
v_mfma_f32_16x16x32_bf16 v[84:87], v[22:25], v[52:55], v[108:111]
v_exp_f32 v101, v77
v_exp_f32 v102, v78
v_exp_f32 v103, v79
v_pk_fma_f32 v[72:73], v[72:73], v[88:89], v[64:65]
v_pk_fma_f32 v[74:75], v[74:75], v[90:91], v[66:67]
v_pk_fma_f32 v[76:77], v[76:77], v[92:93], v[68:69]
v_pk_fma_f32 v[78:79], v[78:79], v[94:95], v[70:71]
v_pk_fma_f32 v[88:89], v[88:89], v[96:97], v[88:89]
v_pk_fma_f32 v[90:91], v[90:91], v[98:99], v[90:91]
v_pk_fma_f32 v[92:93], v[92:93], v[100:101], v[92:93]
v_pk_fma_f32 v[94:95], v[94:95], v[102:103], v[94:95]
v_pk_fma_f32 v[64:65], v[64:65], v[96:97], v[72:73]
v_pk_fma_f32 v[66:67], v[66:67], v[98:99], v[74:75]
v_pk_fma_f32 v[68:69], v[68:69], v[100:101], v[76:77]
v_pk_fma_f32 v[70:71], v[70:71], v[102:103], v[78:79]
s_cbranch_scc0 k_nh2
ds_read_b64_tr_b16 v[48:49], v122 offset:16384
ds_read_b64_tr_b16 v[50:51], v122 offset:20480
ds_read_b64_tr_b16 v[52:53], v1 offset:16384
ds_read_b64_tr_b16 v[54:55], v1 offset:20480
k_nh2:
v_exp_f32 v96, v80
v_exp_f32 v97, v81
s_waitcnt vmcnt(0)
v_mfma_f32_16x16x32_bf16 v[72:75], v[28:31], v[56:59], v[104:107]
v_exp_f32 v98, v82
v_exp_f32 v99, v83
v_exp_f32 v100, v84
v_mfma_f32_16x16x32_bf16 v[76:79], v[26:29], v[60:63], v[108:111]
v_exp_f32 v101, v85
v_exp_f32 v102, v86
v_exp_f32 v103, v87
v_pk_fma_f32 v[80:81], v[80:81], v[88:89], v[64:65]
v_pk_fma_f32 v[82:83], v[82:83], v[90:91], v[66:67]
v_pk_fma_f32 v[84:85], v[84:85], v[92:93], v[68:69]
v_pk_fma_f32 v[86:87], v[86:87], v[94:95], v[70:71]
v_pk_fma_f32 v[88:89], v[88:89], v[96:97], v[88:89]
v_pk_fma_f32 v[90:91], v[90:91], v[98:99], v[90:91]
v_pk_fma_f32 v[92:93], v[92:93], v[100:101], v[92:93]
v_pk_fma_f32 v[94:95], v[94:95], v[102:103], v[94:95]
v_pk_fma_f32 v[64:65], v[64:65], v[96:97], v[80:81]
v_pk_fma_f32 v[66:67], v[66:67], v[98:99], v[82:83]
v_pk_fma_f32 v[68:69], v[68:69], v[100:101], v[84:85]
v_pk_fma_f32 v[70:71], v[70:71], v[102:103], v[86:87]
s_cbranch_scc0 k_nh3
ds_read_b64_tr_b16 v[56:57], v122 offset:24576
ds_read_b64_tr_b16 v[58:59], v122 offset:28672
ds_read_b64_tr_b16 v[60:61], v1 offset:24576
ds_read_b64_tr_b16 v[62:63], v1 offset:28672
k_nh3:
v_exp_f32 v96, v72
v_exp_f32 v97, v73
v_exp_f32 v98, v74
v_exp_f32 v99, v75
v_exp_f32 v100, v76
v_exp_f32 v101, v77
v_exp_f32 v102, v78
v_exp_f32 v103, v79
v_pk_fma_f32 v[72:73], v[72:73], v[88:89], v[64:65]
v_pk_fma_f32 v[74:75], v[74:75], v[90:91], v[66:67]
v_pk_fma_f32 v[76:77], v[76:77], v[92:93], v[68:69]
v_pk_fma_f32 v[78:79], v[78:79], v[94:95], v[70:71]
v_pk_fma_f32 v[88:89], v[88:89], v[96:97], v[88:89]
v_pk_fma_f32 v[90:91], v[90:91], v[98:99], v[90:91]
v_pk_fma_f32 v[92:93], v[92:93], v[100:101], v[92:93]
v_pk_fma_f32 v[94:95], v[94:95], v[102:103], v[94:95]
v_pk_fma_f32 v[64:65], v[64:65], v[96:97], v[72:73]
v_pk_fma_f32 v[66:67], v[66:67], v[98:99], v[74:75]
v_pk_fma_f32 v[68:69], v[68:69], v[100:101], v[76:77]
v_pk_fma_f32 v[70:71], v[70:71], v[102:103], v[78:79]
v_rcp_f32 v88, v88
v_rcp_f32 v89, v89
v_rcp_f32 v90, v90
v_rcp_f32 v91, v91
v_rcp_f32 v92, v92
v_rcp_f32 v93, v93
v_rcp_f32 v94, v94
v_rcp_f32 v95, v95
v_pk_fma_f32 v[88:89], v[64:65], v[88:89], s[44:45]
v_pk_fma_f32 v[90:91], v[66:67], v[90:91], s[44:45]
v_pk_fma_f32 v[92:93], v[68:69], v[92:93], s[44:45]
v_pk_fma_f32 v[94:95], v[70:71], v[94:95], s[44:45]
ds_add_u64 v3, v[88:89] offset:25600
ds_add_u64 v3, v[90:91] offset:25608
ds_add_u64 v3, v[92:93] offset:38400
ds_add_u64 v3, v[94:95] offset:38408
k_epi:
v_xor_b32 v1, 32, v122
v_xor_b32 v2, 64, v123
v_xor_b32 v3, 128, v123
v_xor_b32 v4, 192, v123
s_mov_b32 s28, s16
s_mov_b32 s29, s17
s_mov_b32 s30, 3200000
s_mov_b32 s31, 0x00020000
s_mul_i32 s56, s3, 12544
s_cmp_gt_u32 s48, 11
s_cselect_b32 s57, 0x10001, -1
s_mov_b32 s44, 0xbfb8aa3b
s_mov_b32 s45, s44
s_waitcnt vmcnt(0) lgkmcnt(0)
s_barrier
s_mov_b64 exec, s[60:61]
ds_read_b128 v[64:67], v120 offset:25600
ds_read_b128 v[68:71], v120 offset:38400
s_cmp_ge_u32 s58, 0xffff0000
s_cbranch_scc1 k_trd
s_mov_b64 exec, -1
ds_read_b64_tr_b16 v[32:33], v122 offset:0
ds_read_b64_tr_b16 v[34:35], v122 offset:4096
ds_read_b64_tr_b16 v[36:37], v1 offset:0
ds_read_b64_tr_b16 v[38:39], v1 offset:4096
ds_read_b64_tr_b16 v[40:41], v122 offset:8192
ds_read_b64_tr_b16 v[42:43], v122 offset:12288
ds_read_b64_tr_b16 v[44:45], v1 offset:8192
ds_read_b64_tr_b16 v[46:47], v1 offset:12288
ds_read_b64_tr_b16 v[48:49], v122 offset:16384
ds_read_b64_tr_b16 v[50:51], v122 offset:20480
ds_read_b64_tr_b16 v[52:53], v1 offset:16384
ds_read_b64_tr_b16 v[54:55], v1 offset:20480
ds_read_b64_tr_b16 v[56:57], v122 offset:24576
ds_read_b64_tr_b16 v[58:59], v122 offset:28672
ds_read_b64_tr_b16 v[60:61], v1 offset:24576
ds_read_b64_tr_b16 v[62:63], v1 offset:28672
k_trd:
s_mov_b64 exec, s[60:61]
s_cbranch_execz k_p1_done
s_waitcnt lgkmcnt(0)
s_cmp_lg_u32 s50, 0
s_cbranch_scc1 k_p1_x
v_cvt_f32_i32 v64, v64
v_cvt_f32_i32 v65, v65
v_cvt_f32_i32 v66, v66
v_cvt_f32_i32 v67, v67
v_cvt_f32_i32 v68, v68
v_cvt_f32_i32 v69, v69
v_cvt_f32_i32 v70, v70
v_cvt_f32_i32 v71, v71
k_p1_x:
v_pk_mul_f32 v[64:65], v[64:65], s[46:47]
v_pk_mul_f32 v[66:67], v[66:67], s[46:47]
v_pk_mul_f32 v[68:69], v[68:69], s[46:47]
v_pk_mul_f32 v[70:71], v[70:71], s[46:47]
v_cvt_pk_bf16_f32 v72, v64, v65
v_cvt_pk_bf16_f32 v73, v66, v67
v_cvt_pk_bf16_f32 v74, v68, v69
v_cvt_pk_bf16_f32 v75, v70, v71
ds_write_b128 v121, v[72:75] offset:0
k_p1_done:
s_mov_b32 exec_lo, s57
s_mov_b32 exec_hi, s57
s_waitcnt lgkmcnt(0)
s_barrier
ds_read_b128 v[64:67], v123 offset:0
ds_read_b128 v[68:71], v2 offset:0
ds_read_b128 v[72:75], v3 offset:0
ds_read_b128 v[76:79], v4 offset:0
s_mov_b64 exec, -1
s_waitcnt lgkmcnt(3)
v_mfma_f32_16x16x32_bf16 v[112:115], v[32:35], v[64:67], v[112:115]
v_mfma_f32_16x16x32_bf16 v[116:119], v[36:39], v[64:67], v[116:119]
s_waitcnt lgkmcnt(2)
v_mfma_f32_16x16x32_bf16 v[112:115], v[40:43], v[68:71], v[112:115]
v_mfma_f32_16x16x32_bf16 v[116:119], v[44:47], v[68:71], v[116:119]
s_waitcnt lgkmcnt(1)
v_mfma_f32_16x16x32_bf16 v[112:115], v[48:51], v[72:75], v[112:115]
v_mfma_f32_16x16x32_bf16 v[116:119], v[52:55], v[72:75], v[116:119]
s_waitcnt lgkmcnt(0)
v_mfma_f32_16x16x32_bf16 v[112:115], v[56:59], v[76:79], v[112:115]
v_mfma_f32_16x16x32_bf16 v[116:119], v[60:63], v[76:79], v[116:119]
s_cmp_gt_u32 s48, 11
s_cbranch_scc1 k_r3
s_nop 4
v_pk_mul_f32 v[96:97], v[112:113], s[44:45]
v_pk_mul_f32 v[98:99], v[114:115], s[44:45]
v_pk_mul_f32 v[100:101], v[116:117], s[44:45]
v_pk_mul_f32 v[102:103], v[118:119], s[44:45]
v_exp_f32 v96, v96
v_exp_f32 v97, v97
v_exp_f32 v98, v98
v_exp_f32 v99, v99
v_exp_f32 v100, v100
v_exp_f32 v101, v101
v_exp_f32 v102, v102
v_exp_f32 v103, v103
v_pk_add_f32 v[96:97], v[96:97], 1.0 op_sel_hi:[1,0]
v_pk_add_f32 v[98:99], v[98:99], 1.0 op_sel_hi:[1,0]
v_pk_add_f32 v[100:101], v[100:101], 1.0 op_sel_hi:[1,0]
v_pk_add_f32 v[102:103], v[102:103], 1.0 op_sel_hi:[1,0]
v_rcp_f32 v96, v96
v_rcp_f32 v97, v97
v_rcp_f32 v98, v98
v_rcp_f32 v99, v99
v_rcp_f32 v100, v100
v_rcp_f32 v101, v101
v_rcp_f32 v102, v102
v_rcp_f32 v103, v103
v_pk_mul_f32 v[112:113], v[112:113], v[96:97]
v_pk_mul_f32 v[114:115], v[114:115], v[98:99]
v_pk_mul_f32 v[116:117], v[116:117], v[100:101]
v_pk_mul_f32 v[118:119], v[118:119], v[102:103]
v_cvt_pk_bf16_f32 v24, v112, v113
v_cvt_pk_bf16_f32 v25, v114, v115
v_cvt_pk_bf16_f32 v26, v116, v117
v_cvt_pk_bf16_f32 v27, v118, v119
s_nop 0
v_permlane16_swap_b32 v24, v26
v_permlane16_swap_b32 v25, v27
buffer_store_dwordx4 v[24:27], v124, s[28:31], s56 offen sc0 sc1
k_fin:
k_end:
s_endpgm
k_r3:
s_nop 7
s_nop 1
v_mov_b32_dpp v112, v113 row_shr:1 row_mask:0xf bank_mask:0xf
s_nop 1
v_mov_b32_dpp v112, v114 row_shr:2 row_mask:0xf bank_mask:0xf
s_nop 1
v_mov_b32_dpp v112, v115 row_shr:3 row_mask:0xf bank_mask:0xf
s_nop 1
v_mov_b32_dpp v112, v116 row_shr:4 row_mask:0xf bank_mask:0xf
s_nop 1
v_mov_b32_dpp v112, v117 row_shr:5 row_mask:0xf bank_mask:0xf
s_nop 1
v_mov_b32_dpp v112, v118 row_shr:6 row_mask:0xf bank_mask:0xf
s_nop 1
v_mov_b32_dpp v112, v119 row_shr:7 row_mask:0xf bank_mask:0xf
v_mul_f32 v96, s44, v112
v_exp_f32 v96, v96
s_nop 0
v_add_f32 v96, 1.0, v96
v_rcp_f32 v96, v96
s_nop 0
v_mul_f32 v112, v112, v96
v_cvt_pk_bf16_f32 v24, v112, v112
s_mov_b32 exec_lo, 0x00ff00ff
s_mov_b32 exec_hi, 0x00ff00ff
buffer_store_short v24, v124, s[28:31], s56 offen sc0 sc1
s_branch k_fin
k_nc:
s_mov_b32 s34, 528384
s_cmp_lt_u32 s48, 12
s_cbranch_scc1 k_nc1
s_cmp_eq_u32 s50, 3
s_cbranch_scc1 k_slowd
v_add_u32 v113, 512000, v2
s_cmp_lg_u32 s50, 0
s_cselect_b32 s55, 0, 40
k_fw:
s_sub_u32 s55, s55, 1
s_cbranch_scc1 k_fw2
s_sleep 2
ds_read_b32 v52, v114 offset:51452
s_waitcnt lgkmcnt(0)
v_readfirstlane_b32 s54, v52
s_cmp_eq_u32 s54, 98816
s_cbranch_scc1 k_fw
k_fw2:
buffer_load_dwordx4 v[44:47], v113, s[32:35], 0 offen sc0 sc1
k_fn:
ds_read_b64 v[52:53], v114 offset:51408
s_waitcnt lgkmcnt(0)
v_readfirstlane_b32 s54, v52
v_readfirstlane_b32 s55, v53
s_cmp_eq_u32 s54, 0
s_cbranch_scc1 k_fn
s_and_b32 s55, s55, 31
k_pf:
s_waitcnt vmcnt(0)
v_lshrrev_b64 v[52:53], 27, v[44:45]
v_lshrrev_b64 v[54:55], 27, v[46:47]
v_cmp_ne_u64 s[56:57], s[54:55], v[52:53]
v_cmp_ne_u64 vcc, s[54:55], v[54:55]
s_or_b64 exec, vcc, s[56:57]
s_cbranch_scc1 k_pf2
s_mov_b64 exec, -1
v_max_u32_dpp v44, v44, v44 row_shr:1
v_max_u32_dpp v46, v46, v46 row_shr:1
s_nop 0
v_max_u32_dpp v44, v44, v44 row_shr:2
v_max_u32_dpp v46, v46, v46 row_shr:2
s_nop 0
v_max_u32_dpp v44, v44, v44 row_shr:4
v_max_u32_dpp v46, v46, v46 row_shr:4
s_nop 0
v_max_u32_dpp v44, v44, v44 row_shr:8
v_max_u32_dpp v46, v46, v46 row_shr:8
s_nop 0
v_max_u32_dpp v44, v44, v44 row_bcast:15 row_mask:0xa
v_max_u32_dpp v46, v46, v46 row_bcast:15 row_mask:0xa
s_nop 0
v_max_u32_dpp v44, v44, v44 row_bcast:31 row_mask:0xc
v_max_u32_dpp v46, v46, v46 row_bcast:31 row_mask:0xc
s_mov_b32 exec_lo, 0
s_mov_b32 exec_hi, 0x80000000
ds_max_u32 v114, v44 offset:51436
ds_max_u32 v114, v46 offset:51432
k_nc1:
s_cmp_eq_u32 s50, 0
s_cbranch_scc1 k_ba
s_branch k_slowd
k_pf2:
buffer_load_dwordx4 v[44:47], v113, s[32:35], 0 offen sc0 sc1
s_sub_u32 s53, s53, 1
s_cbranch_scc0 k_pf
v_subrev_u32 v52, 524288, v113
v_lshrrev_b32 v52, 4, v52
v_add_u32 v52, 1073741825, v52
ds_write_b32 v114, v52 offset:51400
s_waitcnt vmcnt(0)
s_branch k_nc1
k_sp1c:
ds_read_b32 v15, v14 offset:51420
s_waitcnt lgkmcnt(0)
v_readfirstlane_b32 s61, v15
s_cmp_lt_u32 s61, 112
s_cbranch_scc1 k_sp1c
s_branch k_sp1
k_sp2c:
ds_read_b32 v15, v14 offset:51416
s_waitcnt lgkmcnt(0)
v_readfirstlane_b32 s61, v15
s_cmp_lt_u32 s61, 128
s_cbranch_scc1 k_sp2c
s_branch k_sp2
k_sp1hc:
ds_read_b32 v15, v6 offset:51420
s_waitcnt lgkmcnt(0)
v_readfirstlane_b32 s61, v15
s_cmp_lt_u32 s61, 112
s_cbranch_scc1 k_sp1hc
s_branch k_sp1h
k_cw:
s_waitcnt vmcnt(0)
s_branch k_common
k_pollh:
s_waitcnt vmcnt(1)
s_branch k_poll1
k_ld3:
s_mov_b64 exec, s[10:11]
buffer_load_dwordx4 v[76:79], v48, s[28:31], 0 offen offset:192 sc0 sc1
s_mov_b64 exec, s[42:43]
buffer_load_dwordx4 v[100:103], v49, s[28:31], s59 offen offset:192 sc0 sc1
s_mov_b64 exec, -1
v_cmp_lt_i32 s[12:13], 16, v50
v_cmp_lt_i32 s[44:45], 16, v51
s_or_b64 vcc, s[12:13], s[44:45]
s_cbranch_scc0 k_common
v_cmp_lt_i32 s[96:97], 20, v50
v_cmp_lt_i32 s[46:47], 20, v51
v_max_i32 v52, v50, v51
v_cmp_lt_i32 vcc, 24, v52
s_mov_b64 exec, s[12:13]
buffer_load_dwordx4 v[80:83], v48, s[28:31], 0 offen offset:256 sc0 sc1
s_mov_b64 exec, s[44:45]
buffer_load_dwordx4 v[104:107], v49, s[28:31], s59 offen offset:256 sc0 sc1
s_mov_b64 exec, s[96:97]
buffer_load_dwordx4 v[84:87], v48, s[28:31], 0 offen offset:320 sc0 sc1
s_mov_b64 exec, s[46:47]
buffer_load_dwordx4 v[108:111], v49, s[28:31], s59 offen offset:320 sc0 sc1
s_mov_b64 exec, vcc
v_mov_b32 v52, 1073741824
ds_write_b32 v114, v52 offset:51396
s_branch k_ld3r
k_rk3:
s_mov_b64 exec, s[10:11]
v_lshlrev_b32_sdwa v35, 2, v78 dst_sel:DWORD dst_unused:UNUSED_PAD src0_sel:DWORD src1_sel:BYTE_3
ds_add_rtn_u32 v79, v35, v1 offset:51200
s_mov_b64 exec, s[42:43]
v_lshlrev_b32_sdwa v41, 2, v102 dst_sel:DWORD dst_unused:UNUSED_PAD src0_sel:DWORD src1_sel:BYTE_3
ds_add_rtn_u32 v103, v41, v1 offset:51200
s_or_b64 s[56:57], s[12:13], s[44:45]
s_cbranch_scc0 k_rk3r
s_mov_b64 exec, s[12:13]
v_lshlrev_b32_sdwa v36, 2, v82 dst_sel:DWORD dst_unused:UNUSED_PAD src0_sel:DWORD src1_sel:BYTE_3
ds_add_rtn_u32 v83, v36, v1 offset:51200
s_mov_b64 exec, s[44:45]
v_lshlrev_b32_sdwa v42, 2, v106 dst_sel:DWORD dst_unused:UNUSED_PAD src0_sel:DWORD src1_sel:BYTE_3
ds_add_rtn_u32 v107, v42, v1 offset:51200
s_mov_b64 exec, s[96:97]
v_lshlrev_b32_sdwa v37, 2, v86 dst_sel:DWORD dst_unused:UNUSED_PAD src0_sel:DWORD src1_sel:BYTE_3
ds_add_rtn_u32 v87, v37, v1 offset:51200
s_mov_b64 exec, s[46:47]
v_lshlrev_b32_sdwa v43, 2, v110 dst_sel:DWORD dst_unused:UNUSED_PAD src0_sel:DWORD src1_sel:BYTE_3
ds_add_rtn_u32 v111, v43, v1 offset:51200
s_branch k_rk3r
k_pl3:
s_mov_b64 exec, s[10:11]
v_min_u32 v79, 163824, v79
v_and_b32 v35, 63, v79
ds_write_b96 v79, v[76:78]
v_cmp_eq_u32 s[10:11], 0, v35
v_mov_b32 v35, s56
s_nop 0
v_mbcnt_lo_u32_b32 v35, s10, v35
v_mbcnt_hi_u32_b32 v35, s11, v35
s_bcnt1_i32_b64 s57, s[10:11]
s_add_u32 s56, s56, s57
s_mov_b64 exec, s[42:43]
v_min_u32 v103, 163824, v103
v_and_b32 v41, 63, v103
ds_write_b96 v103, v[100:102]
v_cmp_eq_u32 s[42:43], 0, v41
v_mov_b32 v41, s56
s_nop 0
v_mbcnt_lo_u32_b32 v41, s42, v41
v_mbcnt_hi_u32_b32 v41, s43, v41
s_bcnt1_i32_b64 s57, s[42:43]
s_add_u32 s56, s56, s57
s_or_b64 vcc, s[12:13], s[44:45]
s_cbranch_scc0 k_pl4
s_mov_b64 exec, s[12:13]
v_min_u32 v83, 163824, v83
v_and_b32 v36, 63, v83
ds_write_b96 v83, v[80:82]
v_cmp_eq_u32 s[12:13], 0, v36
v_mov_b32 v36, s56
s_nop 0
v_mbcnt_lo_u32_b32 v36, s12, v36
v_mbcnt_hi_u32_b32 v36, s13, v36
s_bcnt1_i32_b64 s57, s[12:13]
s_add_u32 s56, s56, s57
s_mov_b64 exec, s[44:45]
v_min_u32 v107, 163824, v107
v_and_b32 v42, 63, v107
ds_write_b96 v107, v[104:106]
v_cmp_eq_u32 s[44:45], 0, v42
v_mov_b32 v42, s56
s_nop 0
v_mbcnt_lo_u32_b32 v42, s44, v42
v_mbcnt_hi_u32_b32 v42, s45, v42
s_bcnt1_i32_b64 s57, s[44:45]
s_add_u32 s56, s56, s57
s_mov_b64 exec, s[96:97]
v_min_u32 v87, 163824, v87
v_and_b32 v37, 63, v87
ds_write_b96 v87, v[84:86]
v_cmp_eq_u32 s[96:97], 0, v37
v_mov_b32 v37, s56
s_nop 0
v_mbcnt_lo_u32_b32 v37, s96, v37
v_mbcnt_hi_u32_b32 v37, s97, v37
s_bcnt1_i32_b64 s57, s[96:97]
s_add_u32 s56, s56, s57
s_mov_b64 exec, s[46:47]
v_min_u32 v111, 163824, v111
v_and_b32 v43, 63, v111
ds_write_b96 v111, v[108:110]
v_cmp_eq_u32 s[46:47], 0, v43
v_mov_b32 v43, s56
s_nop 0
v_mbcnt_lo_u32_b32 v43, s46, v43
v_mbcnt_hi_u32_b32 v43, s47, v43
s_bcnt1_i32_b64 s57, s[46:47]
s_add_u32 s56, s56, s57
k_pl4:
s_lshl_b32 s56, s56, 3
s_mov_b64 exec, 1
v_mov_b32 v52, s56
ds_add_rtn_u32 v52, v114, v52 offset:51452
s_waitcnt lgkmcnt(0)
v_readfirstlane_b32 s56, v52
s_mov_b64 exec, s[10:11]
s_nop 0
v_lshl_add_u32 v35, v35, 3, s56
ds_write_b64 v35, v[78:79]
s_mov_b64 exec, s[42:43]
v_lshl_add_u32 v41, v41, 3, s56
ds_write_b64 v41, v[102:103]
s_cbranch_vccz k_pl3r
s_mov_b64 exec, s[12:13]
v_lshl_add_u32 v36, v36, 3, s56
ds_write_b64 v36, v[82:83]
s_mov_b64 exec, s[44:45]
v_lshl_add_u32 v42, v42, 3, s56
ds_write_b64 v42, v[106:107]
s_mov_b64 exec, s[96:97]
v_lshl_add_u32 v37, v37, 3, s56
ds_write_b64 v37, v[86:87]
s_mov_b64 exec, s[46:47]
v_lshl_add_u32 v43, v43, 3, s56
ds_write_b64 v43, v[110:111]
s_branch k_pl3r
k_pfq:
s_mov_b64 exec, -1
ds_read_b32 v52, v114 offset:50948
s_branch k_rk3r
k_poll2:
s_mov_b64 exec, s[12:13]
buffer_load_dwordx2 v[116:117], v3, s[32:35], s52 offen sc0 sc1
s_mov_b64 exec, vcc
buffer_load_dwordx2 v[118:119], v3, s[32:35], s49 offen sc0 sc1
s_mov_b64 exec, -1
s_sub_u32 s53, s53, 1
s_waitcnt vmcnt(0)
s_cbranch_scc0 k_poll1
v_mov_b32 v52, 1073741953
v_mov_b32 v53, 1073741825
v_cndmask_b32 v52, v53, v52, vcc
v_lshrrev_b32 v53, 11, v3
v_add_u32 v52, v52, v53
s_mov_b64 exec, s[10:11]
ds_write_b32 v114, v52 offset:51400
s_mov_b64 s[4:5], 0
s_mov_b64 s[6:7], 0
s_mov_b64 s[8:9], 0
s_mov_b64 s[10:11], 0
s_mov_b64 s[98:99], 0
s_mov_b64 s[100:101], 0
s_mov_b64 s[40:41], 0
s_mov_b64 s[42:43], 0
s_mov_b32 s53, 0
s_branch k_ld3r
k_retry:
s_sub_u32 s53, s53, 1
s_cbranch_scc1 k_rtmo
v_cmp_ne_u32 vcc, s54, v67
s_mov_b64 exec, vcc
buffer_load_dwordx4 v[64:67], v48, s[28:31], 0 offen offset:0 sc0 sc1
s_mov_b64 exec, -1
v_cmp_ne_u32 vcc, s54, v91
s_mov_b64 exec, vcc
buffer_load_dwordx4 v[88:91], v49, s[28:31], s59 offen offset:0 sc0 sc1
s_mov_b64 exec, -1
v_cmp_ne_u32 vcc, s54, v71
s_mov_b64 exec, vcc
buffer_load_dwordx4 v[68:71], v48, s[28:31], 0 offen offset:64 sc0 sc1
s_mov_b64 exec, -1
v_cmp_ne_u32 vcc, s54, v95
s_mov_b64 exec, vcc
buffer_load_dwordx4 v[92:95], v49, s[28:31], s59 offen offset:64 sc0 sc1
s_mov_b64 exec, -1
v_cmp_ne_u32 vcc, s54, v75
s_mov_b64 exec, vcc
buffer_load_dwordx4 v[72:75], v48, s[28:31], 0 offen offset:128 sc0 sc1
s_mov_b64 exec, -1
v_cmp_ne_u32 vcc, s54, v99
s_mov_b64 exec, vcc
buffer_load_dwordx4 v[96:99], v49, s[28:31], s59 offen offset:128 sc0 sc1
s_mov_b64 exec, -1
v_cmp_ne_u32 vcc, s54, v79
s_mov_b64 exec, vcc
buffer_load_dwordx4 v[76:79], v48, s[28:31], 0 offen offset:192 sc0 sc1
s_mov_b64 exec, -1
v_cmp_ne_u32 vcc, s54, v103
s_mov_b64 exec, vcc
buffer_load_dwordx4 v[100:103], v49, s[28:31], s59 offen offset:192 sc0 sc1
s_mov_b64 exec, -1
v_cmp_ne_u32 vcc, s54, v83
s_mov_b64 exec, vcc
buffer_load_dwordx4 v[80:83], v48, s[28:31], 0 offen offset:256 sc0 sc1
s_mov_b64 exec, -1
v_cmp_ne_u32 vcc, s54, v107
s_mov_b64 exec, vcc
buffer_load_dwordx4 v[104:107], v49, s[28:31], s59 offen offset:256 sc0 sc1
s_mov_b64 exec, -1
v_cmp_ne_u32 vcc, s54, v87
s_mov_b64 exec, vcc
buffer_load_dwordx4 v[84:87], v48, s[28:31], 0 offen offset:320 sc0 sc1
s_mov_b64 exec, -1
v_cmp_ne_u32 vcc, s54, v111
s_mov_b64 exec, vcc
buffer_load_dwordx4 v[108:111], v49, s[28:31], s59 offen offset:320 sc0 sc1
s_mov_b64 exec, -1
s_cmp_eq_u32 s50, 0
s_cbranch_scc1 k_chk
s_branch k_schk
k_rtmo:
s_mov_b64 exec, vcc
v_cmp_ne_u32 vcc, 0, v55
v_mov_b32 v52, 1073741953
v_mov_b32 v53, 1073741825
v_cndmask_b32 v52, v53, v52, vcc
v_mbcnt_lo_u32_b32 v53, -1, 0
v_mbcnt_hi_u32_b32 v53, -1, v53
s_lshl_b32 s56, s48, 6
v_add_u32 v53, s56, v53
v_lshrrev_b32 v53, 2, v53
v_add_u32 v52, v52, v53
ds_write_b32 v114, v52 offset:51400
s_mov_b32 s53, 0
s_branch k_ba
k_non2:
ds_read_b64 v[10:11], v14 offset:51408
s_branch k_non
k_nofb:
s_memrealtime s[54:55]
v_mov_b64 v[66:67], 0
s_waitcnt lgkmcnt(0)
s_or_b32 s54, s54, 1
v_mov_b32 v64, s54
v_mov_b32 v65, s55
s_mov_b64 exec, 1
buffer_atomic_cmpswap_x2 v[64:67], off, s[36:39], 0 sc0 sc1
s_waitcnt vmcnt(0)
s_mov_b64 exec, -1
v_readfirstlane_b32 s60, v64
v_readfirstlane_b32 s61, v65
s_cmp_lg_u32 s60, 0
s_cselect_b64 s[54:55], s[60:61], s[54:55]
v_mov_b32 v10, s54
v_mov_b32 v11, s55
s_branch k_have
k_abn:
v_readlane_b32 s56, v96, 50
v_readlane_b32 s51, v96, 49
s_cmp_lg_u32 s56, 0
s_cbranch_scc1 k_steal
s_bitcmp1_b32 s50, 0
s_cbranch_scc0 k_abn2
s_cmp_eq_u32 s51, 0
s_cbranch_scc1 k_abnr
s_branch k_abnr2
k_abn2:
s_mov_b32 s50, 1
s_branch k_redo
k_steal:
s_sub_u32 s23, s56, 1073741825
v_mov_b32 v114, 0
s_cmp_lg_u32 s48, 0
s_cbranch_scc1 k_st1
s_mov_b64 s[36:37], s[18:19]
s_movk_i32 s38, 256
s_lshr_b32 s56, s23, 5
s_lshl_b32 s56, s56, 2
s_lshl_b32 s57, 1, s23
v_mov_b32 v100, s57
s_mov_b64 exec, 1
buffer_atomic_or v100, off, s[36:39], s56 offset:32 sc0 sc1
s_waitcnt vmcnt(0)
v_and_b32 v100, s57, v100
ds_write_b32 v114, v100 offset:51404
s_mov_b64 exec, -1
k_st1:
s_waitcnt vmcnt(0) lgkmcnt(0)
s_barrier
ds_read_b32 v100, v114 offset:51404
s_waitcnt lgkmcnt(0)
v_readfirstlane_b32 s56, v100
s_mov_b32 s22, 1
s_cmp_eq_u32 s56, 0
s_cbranch_scc1 k_rst
k_redo:
s_mov_b32 s22, 2
s_mov_b32 s23, s3
k_rst:
s_and_b32 s50, s50, 1
v_mbcnt_lo_u32_b32 v0, -1, 0
v_mbcnt_hi_u32_b32 v0, -1, v0
s_lshl_b32 s56, s48, 6
v_add_u32 v0, s56, v0
s_waitcnt vmcnt(0) lgkmcnt(0)
s_barrier
s_load_dwordx16 s[4:19], s[0:1], 0
s_load_dwordx2 s[20:21], s[0:1], 64
s_branch k_go
k_slowd:
s_mov_b64 exec, -1
s_waitcnt vmcnt(0) lgkmcnt(0)
s_barrier
s_cmp_eq_u32 s50, 3
s_cbranch_scc1 k_slow3
ds_read_b64 v[52:53], v114 offset:51408
v_mov_b32 v54, v0
v_mbcnt_lo_u32_b32 v0, -1, 0
v_mbcnt_hi_u32_b32 v0, -1, v0
s_lshl_b32 s56, s48, 6
v_add_u32 v0, s56, v0
s_lshr_b32 s52, s3, 2
s_lshl_b32 s52, s52, 4
s_and_b32 s53, s3, 1
s_lshl_b32 s53, s53, 3
s_add_u32 s52, s52, s53
s_and_b32 s53, s3, 2
s_lshl_b32 s53, s53, 9
s_add_u32 s52, s52, s53
v_lshrrev_b32 v3, 2, v0
v_lshlrev_b32 v3, 11, v3
v_mov_b32 v0, v54
s_movk_i32 s53, 400
s_mov_b32 s49, 0
s_mov_b64 s[4:5], -1
s_mov_b64 s[6:7], -1
s_mov_b64 s[8:9], -1
s_mov_b64 s[10:11], -1
s_mov_b64 s[12:13], -1
s_mov_b64 s[96:97], -1
s_waitcnt lgkmcnt(0)
v_readfirstlane_b32 s54, v52
v_readfirstlane_b32 s55, v53
s_and_b32 s55, s55, 31
k_spoll:
buffer_load_dwordx2 v[126:127], v3, s[32:35], s52 offen sc0 sc1
s_waitcnt vmcnt(0)
v_lshrrev_b64 v[52:53], 27, v[126:127]
v_cmp_ne_u64 vcc, s[54:55], v[52:53]
s_and_b64 exec, exec, vcc
s_cbranch_scc0 k_slow3
s_sub_u32 s53, s53, 1
s_cbranch_scc0 k_spoll
v_lshrrev_b32 v126, 11, v3
v_add_u32 v126, 1073741825, v126
ds_write_b32 v114, v126 offset:51400
s_waitcnt lgkmcnt(0)
v_mov_b32 v126, 0
s_mov_b32 s53, 0
k_slow3:
s_mov_b64 exec, -1
v_add_u32 v6, s49, v6
s_lshl_b32 s56, s49, 4
v_add_u32 v4, s56, v4
v_mov_b32 v67, s54
v_mov_b32 v71, s54
v_mov_b32 v75, s54
v_mov_b32 v79, s54
v_mov_b32 v83, s54
v_mov_b32 v87, s54
v_mov_b32 v91, s54
v_mov_b32 v95, s54
v_mov_b32 v99, s54
v_mov_b32 v103, s54
v_mov_b32 v107, s54
v_mov_b32 v111, s54
v_bfe_u32 v50, v126, 16, 11
v_add_u32_sdwa v48, v126, v4 dst_sel:DWORD dst_unused:UNUSED_PAD src0_sel:WORD_0 src1_sel:DWORD
v_sub_u32 v50, v50, v6
v_mov_b32 v49, v48
v_cmp_lt_i32 vcc, 0, v50
s_and_b64 s[4:5], s[4:5], vcc
s_mov_b64 exec, s[4:5]
buffer_load_dwordx4 v[64:67], v48, s[28:31], 0 offen offset:0 sc0 sc1
s_mov_b64 exec, -1
v_cmp_lt_i32 vcc, 4, v50
s_and_b64 s[6:7], s[6:7], vcc
s_mov_b64 exec, s[6:7]
buffer_load_dwordx4 v[68:71], v48, s[28:31], 0 offen offset:64 sc0 sc1
s_mov_b64 exec, -1
v_cmp_lt_i32 vcc, 8, v50
s_and_b64 s[8:9], s[8:9], vcc
s_mov_b64 exec, s[8:9]
buffer_load_dwordx4 v[72:75], v48, s[28:31], 0 offen offset:128 sc0 sc1
s_mov_b64 exec, -1
v_cmp_lt_i32 vcc, 12, v50
s_and_b64 s[10:11], s[10:11], vcc
s_mov_b64 exec, s[10:11]
buffer_load_dwordx4 v[76:79], v48, s[28:31], 0 offen offset:192 sc0 sc1
s_mov_b64 exec, -1
v_cmp_lt_i32 vcc, 16, v50
s_and_b64 s[12:13], s[12:13], vcc
s_mov_b64 exec, s[12:13]
buffer_load_dwordx4 v[80:83], v48, s[28:31], 0 offen offset:256 sc0 sc1
s_mov_b64 exec, -1
v_cmp_lt_i32 vcc, 20, v50
s_and_b64 s[96:97], s[96:97], vcc
s_mov_b64 exec, s[96:97]
buffer_load_dwordx4 v[84:87], v48, s[28:31], 0 offen offset:320 sc0 sc1
s_mov_b64 exec, -1
v_cmp_lt_i32 vcc, 24, v50
s_cmp_lg_u64 vcc, 0
s_cselect_b32 s51, 1, 0
k_schk:
s_waitcnt vmcnt(0)
v_bitop3_b32 v52, v67, v71, s54 bitop3:0x7e
v_bitop3_b32 v53, v75, v79, s54 bitop3:0x7e
v_bitop3_b32 v54, v83, v87, s54 bitop3:0x7e
v_bitop3_b32 v55, v91, v95, s54 bitop3:0x7e
v_bitop3_b32 v56, v99, v103, s54 bitop3:0x7e
v_bitop3_b32 v57, v107, v111, s54 bitop3:0x7e
v_or3_b32 v52, v52, v53, v54
v_or3_b32 v55, v55, v56, v57
v_or_b32 v53, v52, v55
v_cmp_ne_u32 vcc, 0, v53
s_cbranch_vccnz k_retry
v_mov_b32 v52, 108160
s_movk_i32 s57, 288
s_mov_b64 exec, s[4:5]
v_lshlrev_b32_sdwa v32, 2, v66 dst_sel:DWORD dst_unused:UNUSED_PAD src0_sel:DWORD src1_sel:BYTE_3
ds_add_rtn_u32 v67, v32, v1 offset:51200
v_mad_u32_u24 v38, v32, s57, v52
s_mov_b64 exec, s[6:7]
v_lshlrev_b32_sdwa v33, 2, v70 dst_sel:DWORD dst_unused:UNUSED_PAD src0_sel:DWORD src1_sel:BYTE_3
ds_add_rtn_u32 v71, v33, v1 offset:51200
v_mad_u32_u24 v39, v33, s57, v52
s_mov_b64 exec, s[8:9]
v_lshlrev_b32_sdwa v34, 2, v74 dst_sel:DWORD dst_unused:UNUSED_PAD src0_sel:DWORD src1_sel:BYTE_3
ds_add_rtn_u32 v75, v34, v1 offset:51200
v_mad_u32_u24 v40, v34, s57, v52
s_mov_b64 exec, s[10:11]
v_lshlrev_b32_sdwa v35, 2, v78 dst_sel:DWORD dst_unused:UNUSED_PAD src0_sel:DWORD src1_sel:BYTE_3
ds_add_rtn_u32 v79, v35, v1 offset:51200
v_mad_u32_u24 v41, v35, s57, v52
s_mov_b64 exec, s[12:13]
v_lshlrev_b32_sdwa v36, 2, v82 dst_sel:DWORD dst_unused:UNUSED_PAD src0_sel:DWORD src1_sel:BYTE_3
ds_add_rtn_u32 v83, v36, v1 offset:51200
v_mad_u32_u24 v42, v36, s57, v52
s_mov_b64 exec, s[96:97]
v_lshlrev_b32_sdwa v37, 2, v86 dst_sel:DWORD dst_unused:UNUSED_PAD src0_sel:DWORD src1_sel:BYTE_3
ds_add_rtn_u32 v87, v37, v1 offset:51200
v_mad_u32_u24 v43, v37, s57, v52
s_mov_b32 s56, 0
s_waitcnt lgkmcnt(0)
s_mov_b64 exec, s[4:5]
s_mov_b64 vcc, 0
v_cmp_lt_u32 vcc, v67, v38
v_and_b32 v32, 63, v67
s_andn2_b64 s[4:5], exec, vcc
s_and_b64 exec, exec, vcc
ds_write_b96 v67, v[64:66]
s_mov_b64 s[98:99], 0
v_cmp_eq_u32 s[98:99], 0, v32
v_mov_b32 v32, s56
s_nop 0
v_mbcnt_lo_u32_b32 v32, s98, v32
v_mbcnt_hi_u32_b32 v32, s99, v32
s_bcnt1_i32_b64 s57, s[98:99]
s_add_u32 s56, s56, s57
s_mov_b64 exec, s[6:7]
s_mov_b64 vcc, 0
v_cmp_lt_u32 vcc, v71, v39
v_and_b32 v33, 63, v71
s_andn2_b64 s[6:7], exec, vcc
s_and_b64 exec, exec, vcc
ds_write_b96 v71, v[68:70]
s_mov_b64 s[100:101], 0
v_cmp_eq_u32 s[100:101], 0, v33
v_mov_b32 v33, s56
s_nop 0
v_mbcnt_lo_u32_b32 v33, s100, v33
v_mbcnt_hi_u32_b32 v33, s101, v33
s_bcnt1_i32_b64 s57, s[100:101]
s_add_u32 s56, s56, s57
s_mov_b64 exec, s[8:9]
s_mov_b64 vcc, 0
v_cmp_lt_u32 vcc, v75, v40
v_and_b32 v34, 63, v75
s_andn2_b64 s[8:9], exec, vcc
s_and_b64 exec, exec, vcc
ds_write_b96 v75, v[72:74]
s_mov_b64 s[40:41], 0
v_cmp_eq_u32 s[40:41], 0, v34
v_mov_b32 v34, s56
s_nop 0
v_mbcnt_lo_u32_b32 v34, s40, v34
v_mbcnt_hi_u32_b32 v34, s41, v34
s_bcnt1_i32_b64 s57, s[40:41]
s_add_u32 s56, s56, s57
s_mov_b64 exec, s[10:11]
s_mov_b64 vcc, 0
v_cmp_lt_u32 vcc, v79, v41
v_and_b32 v35, 63, v79
s_andn2_b64 s[10:11], exec, vcc
s_and_b64 exec, exec, vcc
ds_write_b96 v79, v[76:78]
s_mov_b64 s[42:43], 0
v_cmp_eq_u32 s[42:43], 0, v35
v_mov_b32 v35, s56
s_nop 0
v_mbcnt_lo_u32_b32 v35, s42, v35
v_mbcnt_hi_u32_b32 v35, s43, v35
s_bcnt1_i32_b64 s57, s[42:43]
s_add_u32 s56, s56, s57
s_mov_b64 exec, s[12:13]
s_mov_b64 vcc, 0
v_cmp_lt_u32 vcc, v83, v42
v_and_b32 v36, 63, v83
s_andn2_b64 s[12:13], exec, vcc
s_and_b64 exec, exec, vcc
ds_write_b96 v83, v[80:82]
s_mov_b64 s[44:45], 0
v_cmp_eq_u32 s[44:45], 0, v36
v_mov_b32 v36, s56
s_nop 0
v_mbcnt_lo_u32_b32 v36, s44, v36
v_mbcnt_hi_u32_b32 v36, s45, v36
s_bcnt1_i32_b64 s57, s[44:45]
s_add_u32 s56, s56, s57
s_mov_b64 exec, s[96:97]
s_mov_b64 vcc, 0
v_cmp_lt_u32 vcc, v87, v43
v_and_b32 v37, 63, v87
s_andn2_b64 s[96:97], exec, vcc
s_and_b64 exec, exec, vcc
ds_write_b96 v87, v[84:86]
s_mov_b64 s[46:47], 0
v_cmp_eq_u32 s[46:47], 0, v37
v_mov_b32 v37, s56
s_nop 0
v_mbcnt_lo_u32_b32 v37, s46, v37
v_mbcnt_hi_u32_b32 v37, s47, v37
s_bcnt1_i32_b64 s57, s[46:47]
s_add_u32 s56, s56, s57
s_lshl_b32 s56, s56, 3
s_mov_b64 exec, 1
v_mov_b32 v52, s56
ds_add_rtn_u32 v52, v114, v52 offset:51452
s_or_b64 vcc, s[4:5], s[6:7]
s_or_b64 vcc, vcc, s[8:9]
s_or_b64 vcc, vcc, s[10:11]
s_or_b64 vcc, vcc, s[12:13]
s_or_b64 vcc, vcc, s[96:97]
s_cbranch_scc1 k_pend
s_mov_b64 s[4:5], -1
s_mov_b64 s[6:7], -1
s_mov_b64 s[8:9], -1
s_mov_b64 s[10:11], -1
s_mov_b64 s[12:13], -1
s_mov_b64 s[96:97], -1
s_add_u32 s49, s49, 24
s_cmp_eq_u32 s51, 0
s_cbranch_scc1 k_noflag
k_pend:
v_mov_b32 v53, 1073741824
ds_write_b32 v114, v53 offset:51396
k_noflag:
s_waitcnt lgkmcnt(0)
v_readfirstlane_b32 s56, v52
s_mov_b64 exec, s[98:99]
s_nop 0
v_lshl_add_u32 v32, v32, 3, s56
ds_write_b64 v32, v[66:67]
s_mov_b64 exec, s[100:101]
v_lshl_add_u32 v33, v33, 3, s56
ds_write_b64 v33, v[70:71]
s_mov_b64 exec, s[40:41]
v_lshl_add_u32 v34, v34, 3, s56
ds_write_b64 v34, v[74:75]
s_mov_b64 exec, s[42:43]
v_lshl_add_u32 v35, v35, 3, s56
ds_write_b64 v35, v[78:79]
s_mov_b64 exec, s[44:45]
v_lshl_add_u32 v36, v36, 3, s56
ds_write_b64 v36, v[82:83]
s_mov_b64 exec, s[46:47]
v_lshl_add_u32 v37, v37, 3, s56
ds_write_b64 v37, v[86:87]
s_branch k_ba
k_pc_x:
ds_read_b128 v[80:83], v120
ds_read_b128 v[84:87], v120 offset:12800
s_mov_b32 s46, 0xbf317218
s_mov_b32 s47, s46
s_mov_b32 s44, 0x41f80000
s_mov_b32 s45, s44
s_waitcnt lgkmcnt(0)
s_cmp_lg_u32 s51, 0
s_cbranch_scc1 k_pc_y
buffer_load_dwordx4 v125, s[36:39], s58 offen lds
buffer_load_dwordx4 v100, s[36:39], s58 offen offset:1024 lds
k_pc_y:
s_mov_b64 exec, s[60:61]
v_min_u32 v97, 1200, v97
v_and_b32 v97, 48, v97
v_subrev_u32 v97, 48, v97
v_cvt_f32_i32 v76, v97
v_mul_f32 v76, 0x3d800000, v76
v_mov_b32 v77, v76
v_pk_add_f32 v[80:81], v[80:81], s[44:45]
v_pk_add_f32 v[82:83], v[82:83], s[44:45]
v_pk_add_f32 v[84:85], v[84:85], s[44:45]
v_pk_add_f32 v[86:87], v[86:87], s[44:45]
v_exp_f32 v96, v80
v_exp_f32 v97, v81
v_exp_f32 v98, v82
v_exp_f32 v99, v83
v_exp_f32 v100, v84
v_exp_f32 v101, v85
v_exp_f32 v102, v86
v_exp_f32 v103, v87
v_pk_mul_f32 v[80:81], v[80:81], v[76:77]
v_pk_mul_f32 v[82:83], v[82:83], v[76:77]
v_pk_mul_f32 v[84:85], v[84:85], v[76:77]
v_pk_mul_f32 v[86:87], v[86:87], v[76:77]
v_pk_add_f32 v[96:97], v[96:97], 1.0 op_sel_hi:[1,0]
v_pk_add_f32 v[98:99], v[98:99], 1.0 op_sel_hi:[1,0]
v_pk_add_f32 v[100:101], v[100:101], 1.0 op_sel_hi:[1,0]
v_pk_add_f32 v[102:103], v[102:103], 1.0 op_sel_hi:[1,0]
v_rcp_f32 v96, v96
v_rcp_f32 v97, v97
v_rcp_f32 v98, v98
v_rcp_f32 v99, v99
v_rcp_f32 v100, v100
v_rcp_f32 v101, v101
v_rcp_f32 v102, v102
v_rcp_f32 v103, v103
v_pk_mul_f32 v[80:81], v[80:81], v[96:97]
v_pk_mul_f32 v[82:83], v[82:83], v[98:99]
v_pk_mul_f32 v[84:85], v[84:85], v[100:101]
v_pk_mul_f32 v[86:87], v[86:87], v[102:103]
ds_add_f32 v120, v80 offset:25600
ds_add_f32 v120, v81 offset:25604
ds_add_f32 v120, v82 offset:25608
ds_add_f32 v120, v83 offset:25612
ds_add_f32 v120, v84 offset:38400
ds_add_f32 v120, v85 offset:38404
ds_add_f32 v120, v86 offset:38408
ds_add_f32 v120, v87 offset:38412
s_mov_b64 exec, -1
s_cmp_eq_u32 s53, 0
s_cbranch_scc1 k_loop_done
s_waitcnt vmcnt(0) lgkmcnt(0)
v_mfma_f32_16x16x32_bf16 v[64:67], v[16:19], v[32:35], v[104:107]
v_mfma_f32_16x16x32_bf16 v[68:71], v[14:17], v[36:39], v[108:111]
s_cmp_eq_u32 s53, 1
s_cbranch_scc1 k_last_x
k_loop_x:
s_waitcnt lgkmcnt(8)
v_mov_b32 v4, v3
ds_read_u16 v3, v0 offset:514
buffer_load_dwordx4 v[34:37], v[6:7], s[24:27], 0 idxen offen sc0 sc1
s_mov_b64 exec, s[62:63]
ds_read_b64 v[16:17], v2 offset:0
s_mov_b64 exec, -1
ds_read_u16 v6, v1 offset:8
v_exp_f32 v96, v64
v_exp_f32 v97, v65
s_waitcnt vmcnt(3)
v_mfma_f32_16x16x32_bf16 v[72:75], v[20:23], v[40:43], v[104:107]
v_exp_f32 v98, v66
v_exp_f32 v99, v67
v_exp_f32 v100, v68
v_mfma_f32_16x16x32_bf16 v[76:79], v[18:21], v[44:47], v[108:111]
v_exp_f32 v101, v69
v_exp_f32 v102, v70
v_exp_f32 v103, v71
v_pk_add_f32 v[96:97], v[96:97], 1.0 op_sel_hi:[1,0]
v_pk_add_f32 v[98:99], v[98:99], 1.0 op_sel_hi:[1,0]
v_pk_add_f32 v[100:101], v[100:101], 1.0 op_sel_hi:[1,0]
v_pk_add_f32 v[102:103], v[102:103], 1.0 op_sel_hi:[1,0]
v_rcp_f32 v96, v96
v_rcp_f32 v97, v97
v_rcp_f32 v98, v98
v_rcp_f32 v99, v99
v_rcp_f32 v100, v100
v_rcp_f32 v101, v101
v_rcp_f32 v102, v102
v_rcp_f32 v103, v103
v_pk_mul_f32 v[88:89], v[64:65], v[96:97]
v_pk_mul_f32 v[90:91], v[66:67], v[98:99]
v_pk_mul_f32 v[92:93], v[68:69], v[100:101]
v_pk_mul_f32 v[94:95], v[70:71], v[102:103]
buffer_load_dwordx4 v[42:45], v[8:9], s[24:27], 0 idxen offen sc0 sc1
s_mov_b64 exec, s[62:63]
ds_read_b64 v[20:21], v2 offset:16
s_mov_b64 exec, -1
ds_read_u16 v8, v1 offset:24
v_exp_f32 v96, v72
v_exp_f32 v97, v73
s_waitcnt vmcnt(3)
v_mfma_f32_16x16x32_bf16 v[80:83], v[24:27], v[48:51], v[104:107]
v_exp_f32 v98, v74
v_exp_f32 v99, v75
v_exp_f32 v100, v76
v_mfma_f32_16x16x32_bf16 v[84:87], v[22:25], v[52:55], v[108:111]
v_exp_f32 v101, v77
v_exp_f32 v102, v78
v_exp_f32 v103, v79
v_pk_add_f32 v[96:97], v[96:97], 1.0 op_sel_hi:[1,0]
v_pk_add_f32 v[98:99], v[98:99], 1.0 op_sel_hi:[1,0]
v_pk_add_f32 v[100:101], v[100:101], 1.0 op_sel_hi:[1,0]
v_pk_add_f32 v[102:103], v[102:103], 1.0 op_sel_hi:[1,0]
v_rcp_f32 v96, v96
v_rcp_f32 v97, v97
v_rcp_f32 v98, v98
v_rcp_f32 v99, v99
v_rcp_f32 v100, v100
v_rcp_f32 v101, v101
v_rcp_f32 v102, v102
v_rcp_f32 v103, v103
v_pk_fma_f32 v[88:89], v[72:73], v[96:97], v[88:89]
v_pk_fma_f32 v[90:91], v[74:75], v[98:99], v[90:91]
v_pk_fma_f32 v[92:93], v[76:77], v[100:101], v[92:93]
v_pk_fma_f32 v[94:95], v[78:79], v[102:103], v[94:95]
buffer_load_dwordx4 v[50:53], v[10:11], s[24:27], 0 idxen offen sc0 sc1
s_mov_b64 exec, s[62:63]
ds_read_b64 v[24:25], v2 offset:32
s_mov_b64 exec, -1
ds_read_u16 v10, v1 offset:40
v_exp_f32 v96, v80
v_exp_f32 v97, v81
s_waitcnt vmcnt(3) lgkmcnt(6)
v_mfma_f32_16x16x32_bf16 v[72:75], v[28:31], v[56:59], v[104:107]
v_exp_f32 v98, v82
v_exp_f32 v99, v83
v_exp_f32 v100, v84
v_mfma_f32_16x16x32_bf16 v[76:79], v[26:29], v[60:63], v[108:111]
v_exp_f32 v101, v85
v_exp_f32 v102, v86
v_exp_f32 v103, v87
v_xor_b32 v3, v3, v7
ds_read_b128 v[104:107], v3
ds_read_b128 v[108:111], v3 offset:12800
v_pk_add_f32 v[96:97], v[96:97], 1.0 op_sel_hi:[1,0]
v_pk_add_f32 v[98:99], v[98:99], 1.0 op_sel_hi:[1,0]
v_pk_add_f32 v[100:101], v[100:101], 1.0 op_sel_hi:[1,0]
v_pk_add_f32 v[102:103], v[102:103], 1.0 op_sel_hi:[1,0]
v_rcp_f32 v96, v96
v_rcp_f32 v97, v97
v_rcp_f32 v98, v98
v_rcp_f32 v99, v99
v_rcp_f32 v100, v100
v_rcp_f32 v101, v101
v_rcp_f32 v102, v102
v_rcp_f32 v103, v103
v_pk_fma_f32 v[88:89], v[80:81], v[96:97], v[88:89]
v_pk_fma_f32 v[90:91], v[82:83], v[98:99], v[90:91]
v_pk_fma_f32 v[92:93], v[84:85], v[100:101], v[92:93]
v_pk_fma_f32 v[94:95], v[86:87], v[102:103], v[94:95]
buffer_load_dwordx4 v[58:61], v[12:13], s[24:27], 0 idxen offen sc0 sc1
s_mov_b64 exec, s[62:63]
ds_read_b64 v[28:29], v2 offset:48
s_mov_b64 exec, -1
ds_read_u16 v12, v1 offset:56
ds_read_b32 v1, v0 offset:1540
ds_read_b32 v2, v5 offset:1028
v_add_u32 v0, 0x200, v0
v_add_u32 v5, 0x200, v5
v_exp_f32 v96, v72
v_exp_f32 v97, v73
v_exp_f32 v98, v74
v_exp_f32 v99, v75
v_exp_f32 v100, v76
v_exp_f32 v101, v77
v_exp_f32 v102, v78
v_exp_f32 v103, v79
v_pk_add_f32 v[96:97], v[96:97], 1.0 op_sel_hi:[1,0]
v_pk_add_f32 v[98:99], v[98:99], 1.0 op_sel_hi:[1,0]
v_pk_add_f32 v[100:101], v[100:101], 1.0 op_sel_hi:[1,0]
v_pk_add_f32 v[102:103], v[102:103], 1.0 op_sel_hi:[1,0]
v_rcp_f32 v96, v96
v_rcp_f32 v97, v97
v_rcp_f32 v98, v98
v_rcp_f32 v99, v99
v_rcp_f32 v100, v100
v_rcp_f32 v101, v101
v_rcp_f32 v102, v102
v_rcp_f32 v103, v103
v_pk_fma_f32 v[88:89], v[72:73], v[96:97], v[88:89]
v_pk_fma_f32 v[90:91], v[74:75], v[98:99], v[90:91]
v_pk_fma_f32 v[92:93], v[76:77], v[100:101], v[92:93]
v_pk_fma_f32 v[94:95], v[78:79], v[102:103], v[94:95]
s_waitcnt vmcnt(3) lgkmcnt(4)
v_mfma_f32_16x16x32_bf16 v[64:67], v[16:19], v[32:35], v[104:107]
v_mfma_f32_16x16x32_bf16 v[68:71], v[14:17], v[36:39], v[108:111]
ds_add_f32 v4, v88 offset:25600
ds_add_f32 v4, v89 offset:25604
ds_add_f32 v4, v90 offset:25608
ds_add_f32 v4, v91 offset:25612
ds_add_f32 v4, v92 offset:38400
ds_add_f32 v4, v93 offset:38404
ds_add_f32 v4, v94 offset:38408
ds_add_f32 v4, v95 offset:38412
s_sub_u32 s53, s53, 1
s_cmp_gt_u32 s53, 1
s_cbranch_scc1 k_loop_x
k_last_x:
s_waitcnt lgkmcnt(8)
s_nop 3
v_exp_f32 v96, v64
v_exp_f32 v97, v65
s_waitcnt vmcnt(2)
v_mfma_f32_16x16x32_bf16 v[72:75], v[20:23], v[40:43], v[104:107]
v_exp_f32 v98, v66
v_exp_f32 v99, v67
v_exp_f32 v100, v68
v_mfma_f32_16x16x32_bf16 v[76:79], v[18:21], v[44:47], v[108:111]
v_exp_f32 v101, v69
v_exp_f32 v102, v70
v_exp_f32 v103, v71
v_pk_add_f32 v[96:97], v[96:97], 1.0 op_sel_hi:[1,0]
v_pk_add_f32 v[98:99], v[98:99], 1.0 op_sel_hi:[1,0]
v_pk_add_f32 v[100:101], v[100:101], 1.0 op_sel_hi:[1,0]
v_pk_add_f32 v[102:103], v[102:103], 1.0 op_sel_hi:[1,0]
v_rcp_f32 v96, v96
v_rcp_f32 v97, v97
v_rcp_f32 v98, v98
v_rcp_f32 v99, v99
v_rcp_f32 v100, v100
v_rcp_f32 v101, v101
v_rcp_f32 v102, v102
v_rcp_f32 v103, v103
v_pk_mul_f32 v[88:89], v[64:65], v[96:97]
v_pk_mul_f32 v[90:91], v[66:67], v[98:99]
v_pk_mul_f32 v[92:93], v[68:69], v[100:101]
v_pk_mul_f32 v[94:95], v[70:71], v[102:103]
v_exp_f32 v96, v72
v_exp_f32 v97, v73
s_waitcnt vmcnt(1)
v_mfma_f32_16x16x32_bf16 v[80:83], v[24:27], v[48:51], v[104:107]
v_exp_f32 v98, v74
v_exp_f32 v99, v75
v_exp_f32 v100, v76
v_mfma_f32_16x16x32_bf16 v[84:87], v[22:25], v[52:55], v[108:111]
v_exp_f32 v101, v77
v_exp_f32 v102, v78
v_exp_f32 v103, v79
v_pk_add_f32 v[96:97], v[96:97], 1.0 op_sel_hi:[1,0]
v_pk_add_f32 v[98:99], v[98:99], 1.0 op_sel_hi:[1,0]
v_pk_add_f32 v[100:101], v[100:101], 1.0 op_sel_hi:[1,0]
v_pk_add_f32 v[102:103], v[102:103], 1.0 op_sel_hi:[1,0]
v_rcp_f32 v96, v96
v_rcp_f32 v97, v97
v_rcp_f32 v98, v98
v_rcp_f32 v99, v99
v_rcp_f32 v100, v100
v_rcp_f32 v101, v101
v_rcp_f32 v102, v102
v_rcp_f32 v103, v103
v_pk_fma_f32 v[88:89], v[72:73], v[96:97], v[88:89]
v_pk_fma_f32 v[90:91], v[74:75], v[98:99], v[90:91]
v_pk_fma_f32 v[92:93], v[76:77], v[100:101], v[92:93]
v_pk_fma_f32 v[94:95], v[78:79], v[102:103], v[94:95]
v_exp_f32 v96, v80
v_exp_f32 v97, v81
s_waitcnt vmcnt(0)
v_mfma_f32_16x16x32_bf16 v[72:75], v[28:31], v[56:59], v[104:107]
v_exp_f32 v98, v82
v_exp_f32 v99, v83
v_exp_f32 v100, v84
v_mfma_f32_16x16x32_bf16 v[76:79], v[26:29], v[60:63], v[108:111]
v_exp_f32 v101, v85
v_exp_f32 v102, v86
v_exp_f32 v103, v87
v_pk_add_f32 v[96:97], v[96:97], 1.0 op_sel_hi:[1,0]
v_pk_add_f32 v[98:99], v[98:99], 1.0 op_sel_hi:[1,0]
v_pk_add_f32 v[100:101], v[100:101], 1.0 op_sel_hi:[1,0]
v_pk_add_f32 v[102:103], v[102:103], 1.0 op_sel_hi:[1,0]
v_rcp_f32 v96, v96
v_rcp_f32 v97, v97
v_rcp_f32 v98, v98
v_rcp_f32 v99, v99
v_rcp_f32 v100, v100
v_rcp_f32 v101, v101
v_rcp_f32 v102, v102
v_rcp_f32 v103, v103
v_pk_fma_f32 v[88:89], v[80:81], v[96:97], v[88:89]
v_pk_fma_f32 v[90:91], v[82:83], v[98:99], v[90:91]
v_pk_fma_f32 v[92:93], v[84:85], v[100:101], v[92:93]
v_pk_fma_f32 v[94:95], v[86:87], v[102:103], v[94:95]
v_exp_f32 v96, v72
v_exp_f32 v97, v73
v_exp_f32 v98, v74
v_exp_f32 v99, v75
v_exp_f32 v100, v76
v_exp_f32 v101, v77
v_exp_f32 v102, v78
v_exp_f32 v103, v79
v_pk_add_f32 v[96:97], v[96:97], 1.0 op_sel_hi:[1,0]
v_pk_add_f32 v[98:99], v[98:99], 1.0 op_sel_hi:[1,0]
v_pk_add_f32 v[100:101], v[100:101], 1.0 op_sel_hi:[1,0]
v_pk_add_f32 v[102:103], v[102:103], 1.0 op_sel_hi:[1,0]
v_rcp_f32 v96, v96
v_rcp_f32 v97, v97
v_rcp_f32 v98, v98
v_rcp_f32 v99, v99
v_rcp_f32 v100, v100
v_rcp_f32 v101, v101
v_rcp_f32 v102, v102
v_rcp_f32 v103, v103
v_pk_fma_f32 v[88:89], v[72:73], v[96:97], v[88:89]
v_pk_fma_f32 v[90:91], v[74:75], v[98:99], v[90:91]
v_pk_fma_f32 v[92:93], v[76:77], v[100:101], v[92:93]
v_pk_fma_f32 v[94:95], v[78:79], v[102:103], v[94:95]
ds_add_f32 v3, v88 offset:25600
ds_add_f32 v3, v89 offset:25604
ds_add_f32 v3, v90 offset:25608
ds_add_f32 v3, v91 offset:25612
ds_add_f32 v3, v92 offset:38400
ds_add_f32 v3, v93 offset:38404
ds_add_f32 v3, v94 offset:38408
ds_add_f32 v3, v95 offset:38412
k_loop_done:
s_cmp_eq_u32 s51, 0
s_cbranch_scc1 k_epi
v_mbcnt_lo_u32_b32 v0, -1, 0
v_mbcnt_hi_u32_b32 v0, -1, v0
s_lshl_b32 s56, s48, 6
v_add_u32 v0, s56, v0
s_mov_b32 s50, 3
s_waitcnt vmcnt(0) lgkmcnt(0)
s_barrier
v_lshlrev_b32 v2, 4, v0
v_add_u32 v2, 98816, v2
s_add_u32 s56, s3, 12544
v_mov_b64 v[64:65], 0
v_mov_b32 v66, s56
v_mov_b32 v67, 0
ds_write_b128 v2, v[64:67] offset:16384
ds_write_b128 v2, v[64:67] offset:32768
ds_write_b128 v2, v[64:67] offset:48640
s_cmp_gt_u32 s48, 7
s_cbranch_scc1 k_r1
s_waitcnt lgkmcnt(0)
v_mov_b32 v64, 822083584
v_mov_b32 v65, 163456
v_mov_b64 v[66:67], v[64:65]
k_r1:
ds_write_b128 v2, v[64:67]
s_cmp_lg_u32 s48, 15
s_cbranch_scc1 k_round
v_and_b32 v68, 63, v0
s_movk_i32 s56, 1152
v_mov_b32 v69, 107008
v_mad_u32_u24 v69, v68, s56, v69
v_cmp_gt_u32 vcc, 49, v68
s_nop 1
v_cndmask_b32 v69, 0, v69, vcc
s_mov_b32 s56, 98816
v_writelane_b32 v69, s56, 63
v_lshlrev_b32 v68, 2, v68
ds_write_b32 v68, v69 offset:51200
s_branch k_round
code_end:
.section .rodata,"a"
.p2align 6
.amdhsa_kernel gather_scatter__mpnn_edge_mlp__graph_kernel
  .amdhsa_next_free_vgpr 128
  .amdhsa_next_free_sgpr 102
  .amdhsa_accum_offset 128
  .amdhsa_group_segment_fixed_size 0
  .amdhsa_kernarg_size 72
  .amdhsa_user_sgpr_count 2
  .amdhsa_user_sgpr_kernarg_segment_ptr 1
  .amdhsa_system_sgpr_workgroup_id_x 1
.end_amdhsa_kernel
```
